```python
import torch

def _softmax(x, axis=-1):
    return torch.softmax(x, dim=axis)
def _gelu(x):
    return torch.nn.functional.gelu(x, approximate="tanh")
def _silu(x):
    return torch.nn.functional.silu(x)
def _sigmoid(x):
    return torch.sigmoid(x)
def _layernorm(x, axis=-1, eps=1e-5):
    m = x.mean(dim=axis, keepdim=True)
    v = x.var(dim=axis, keepdim=True, unbiased=False)
    return (x - m) / torch.sqrt(v + eps)
def _scatter_add(tgt, idx, src, axis=0):
    return tgt.clone().index_add_(axis, idx, src)
def _segment_sum(src, seg, n):
    out = torch.zeros((n,) + src.shape[1:], dtype=src.dtype)
    return out.index_add_(0, seg, src)
def _pad(x, pw):
    flat = tuple(v for pair in reversed(pw) for v in pair)
    return torch.nn.functional.pad(x, flat)

kernel_name = 'gated_mix__grouped_kv_mqa__moe_arch_mod__prompt'

def setup_inputs():

    _w = (lambda a: (lambda t: t.to(torch.bfloat16) if t.is_floating_point() else t)(torch.as_tensor(a)))
    def _A_setup():
        B, S, D, H = 1, 2048, 640, 32
        Dh = D // H
        return {
            "x": _w((lambda *s: torch.randn(*s, dtype=torch.bfloat16) * 0.05)(B, S, D)),
            "wq": _w((lambda *s: torch.randn(*s, dtype=torch.bfloat16) * 0.8)(D, H * Dh)),
            "wk": _w((lambda *s: torch.randn(*s, dtype=torch.bfloat16) * 0.8)(D, Dh)),
            "wv": _w((lambda *s: torch.randn(*s, dtype=torch.bfloat16) * 0.2)(D, Dh)),
            "wo": _w((lambda *s: torch.randn(*s, dtype=torch.bfloat16) * 0.2)(H * Dh, D)),
        }
    _A_in = _A_setup()

    def _B_setup():
        B, S, D, F, C = 1, 2048, 640, 1536, 1
        return {
            "x": _w((lambda *s: torch.randn(*s, dtype=torch.bfloat16) * 0.05)(B, S, D)),
            "w_r": _w((lambda *s: torch.randn(*s, dtype=torch.bfloat16) * 1.6)(D)),
            "w_gate": _w((lambda *s: torch.randn(*s, dtype=torch.bfloat16) * 0.2)(D, F)),
            "w_up": _w((lambda *s: torch.randn(*s, dtype=torch.bfloat16) * 0.2)(D, F)),
            "w_down": _w((lambda *s: torch.randn(*s, dtype=torch.bfloat16) * 0.2)(F, D)),
        }
    _B_in = _B_setup()

    return {
        "A_x": _A_in["x"],
        "A_wq": _A_in["wq"],
        "A_wk": _A_in["wk"],
        "A_wv": _A_in["wv"],
        "A_wo": _A_in["wo"],
        "B_x": _B_in["x"],
        "B_w_r": _B_in["w_r"],
        "B_w_gate": _B_in["w_gate"],
        "B_w_up": _B_in["w_up"],
        "B_w_down": _B_in["w_down"],
        "gate_w": _w((lambda *s: torch.randn(*s, dtype=torch.bfloat16) * 0.05)(640) * 16.0),
    }

def reference(A_x, A_wq, A_wk, A_wv, A_wo, B_x, B_w_r, B_w_gate, B_w_up, B_w_down, gate_w):
    def _A_ref(x, wq, wk, wv, wo):
        B, S, D = x.shape
        H = 32
        Dh = D // H
        q = (lambda x, *d: x.permute(*d))((x @ wq).reshape(B, S, H, Dh), 0, 2, 1, 3)
        k = x @ wk
        v = x @ wv
        scores = torch.einsum("bhqd,bkd->bhqk", q, k) * (Dh ** -0.5)
        p = _softmax(scores, axis=-1)
        o = torch.einsum("bhqk,bkd->bhqd", p, v)
        return (lambda x, *d: x.permute(*d))(o, 0, 2, 1, 3).reshape(B, S, H * Dh) @ wo

    def _B_ref(x, w_r, w_gate, w_up, w_down):
        B, S, D = x.shape
        C = 1
        r = x @ w_r
        idx = torch.argsort(-r, axis=-1)[:, :C]
        idx_e = (lambda x, n, axis: torch.repeat_interleave(x, n, dim=axis))(idx.reshape(B, C, 1), D, axis=2)
        x_sel = (lambda x, i, axis: torch.take_along_dim(x, i, dim=axis))(x, idx_e, axis=1)
        g = _silu(x_sel @ w_gate)
        u = x_sel @ w_up
        y = (g * u) @ w_down
        r_sel = _sigmoid((lambda x, i, axis: torch.take_along_dim(x, i, dim=axis))(r, idx, axis=1))
        y = y * r_sel.reshape(B, C, 1)
        b_off = (torch.arange(B) * S).reshape(B, 1)
        flat_idx = (idx + b_off).reshape(B * C)
        zero = (x * 0.0).reshape(B * S, D)
        upd = _scatter_add(zero, flat_idx, y.reshape(B * C, D), axis=0)
        return x + upd.reshape(B, S, D)

    x = A_x
    g = _sigmoid((x * gate_w).sum(-1, keepdims=True))
    a = _A_ref(x, A_wq, A_wk, A_wv, A_wo)
    b = _B_ref(x, B_w_r, B_w_gate, B_w_up, B_w_down)
    return g * a + (1 - g) * b
```

```asm
; @launch grid=(256,1,1) block=(576,1,1) lds=163840
.amdgcn_target "amdgcn-amd-amdhsa--gfx950"
.text
.globl gated_mix__grouped_kv_mqa__moe_arch_mod__prompt_kernel
.p2align 8
.type gated_mix__grouped_kv_mqa__moe_arch_mod__prompt_kernel,@function
gated_mix__grouped_kv_mqa__moe_arch_mod__prompt_kernel:

    s_cmp_ge_u32 s2, 256
    s_cbranch_scc1 L_end
    s_load_dwordx16 s[40:55], s[0:1], 0
    s_load_dwordx8 s[56:63], s[0:1], 64
    s_load_dwordx4 s[64:67], s[0:1], 96

    s_getpc_b64 s[68:69]
L_pc:
    s_bfe_u32 s38, s2, 0x20003
    s_min_u32 s38, s38, 2
    s_mul_i32 s38, s38, 9216
    v_lshl_add_u32 v6, v0, 4, s38
    v_min_u32 v6, L_code_end-L_pc-16, v6
    global_load_dwordx4 v[128:131], v6, s[68:69]

    v_lshrrev_b32 v1, 6, v0
    v_and_b32 v145, 63, v0
    v_readfirstlane_b32 s32, v1
    v_and_b32 v153, 31, v0
    v_lshrrev_b32 v154, 5, v145
    v_and_b32 v155, 15, v0
    v_lshrrev_b32 v156, 4, v145
    v_lshlrev_b32 v150, 4, v145
    v_lshlrev_b32 v151, 2, v145
    s_and_b32 s33, s2, 7
    s_lshl_b32 s33, s33, 2
    s_lshr_b32 s38, s2, 6
    s_add_u32 s33, s33, s38
    s_bfe_u32 s34, s2, 0x30003
    s_and_b32 s38, s34, 1
    s_lshl_b32 s35, s33, 1
    s_add_u32 s35, s35, s38
    s_lshr_b32 s36, s34, 1
    s_lshl_b32 s37, s33, 3
    s_add_u32 s37, s37, s34
    s_mov_b32 s4, -1
    s_mov_b32 s5, 0
    s_lshr_b32 s38, s32, 2
    s_xor_b32 s38, s38, s36
    s_xor_b32 s38, s38, 1
    s_and_b32 s38, s38, 1
    s_lshl_b32 s38, s38, 2
    s_and_b32 s39, s32, 3
    s_add_u32 s90, s38, s39
    s_lshl_b32 s38, s90, 2
    v_add_u32 v7, s38, v156
    v_and_b32 v2, 15, v7
    v_xor_b32 v2, v2, v155
    v_mul_u32_u24 v7, 1280, v7
    v_lshl_add_u32 v7, v2, 4, v7
    s_mul_i32 s91, s35, 40960
    s_lshl_b32 s90, s90, 10
    s_waitcnt lgkmcnt(0)

    s_mov_b32 s16, s40
    s_mov_b32 s17, s41
    s_mov_b32 s18, 2621440
    s_mov_b32 s19, 0x00020000
    s_cmp_ge_u32 s36, 2
    s_cselect_b32 s28, s46, s44
    s_cselect_b32 s29, s47, s45
    s_mov_b32 s30, 25600
    s_mov_b32 s31, 0x00020000
    s_sub_u32 s38, s32, 4
    s_cmp_lt_u32 s38, 4
    s_cbranch_scc0 L_nox1

    s_add_u32 m0, s90, 32768
    s_nop 0
    buffer_load_dwordx4 v7, s[16:19], s91 offen offset:0 lds
    s_add_u32 m0, s90, 40704
    s_nop 0
    buffer_load_dwordx4 v7, s[16:19], s91 offen offset:256 lds
    s_add_u32 m0, s90, 48640
    s_nop 0
    buffer_load_dwordx4 v7, s[16:19], s91 offen offset:512 lds
    s_add_u32 m0, s90, 56576
    s_nop 0
    buffer_load_dwordx4 v7, s[16:19], s91 offen offset:768 lds
    s_add_u32 m0, s90, 64512
    s_nop 0
    buffer_load_dwordx4 v7, s[16:19], s91 offen offset:1024 lds
    s_branch L_first_done
L_nox1:
    s_min_u32 s38, s32, 4
    s_mul_i32 s38, s38, 5120
    s_add_u32 m0, s38, 0
    s_add_u32 s39, s38, 4096

    buffer_load_dwordx4 v150, s[28:31], s38 offen offset:0 lds
    buffer_load_dwordx4 v150, s[28:31], s38 offen offset:1024 lds
    buffer_load_dwordx4 v150, s[28:31], s38 offen offset:2048 lds
    buffer_load_dwordx4 v150, s[28:31], s38 offen offset:3072 lds
    s_add_u32 m0, s39, 0
    s_nop 0
    buffer_load_dwordx4 v150, s[28:31], s39 offen lds

L_first_done:
    s_mov_b32 s8, s66
    s_mov_b32 s9, s67
    s_mov_b32 s10, 8388608
    s_mov_b32 s11, 0x00020000
    s_cmp_eq_u32 s32, 8
    s_cbranch_scc1 L_helper

    s_and_b32 s81, s32, 1
    v_lshlrev_b32 v4, 4, v153
    v_mul_u32_u24 v152, 336, v154
    v_add_u32 v152, v152, v4
    v_cmp_lt_u32 vcc, 20, v153
    v_mov_b32 v4, 0x1000000
    s_mul_i32 s39, s81, 2624
    v_cndmask_b32 v152, v152, v4, vcc
    v_add_u32 v146, s39, v150
    v_add_u32 v147, s39, v151
    v_add_u32 v148, s39, v152
    s_mul_i32 s38, s32, 40
    s_xor_b32 s39, s32, 1
    s_mul_i32 s39, s39, 40
    v_mul_u32_u24 v1, 328, v153
    v_add_u32 v1, 139264, v1
    v_lshl_add_u32 v2, v154, 4, v1
    v_lshl_add_u32 v3, v154, 2, v1
    v_add_u32 v149, s39, v2
    v_add_u32 v165, s39, v3
    v_add_u32 v166, s38, v2
    v_add_u32 v167, s38, v3
    v_add_u32 v157, 36736, v146
    v_add_u32 v158, 36736, v147
    v_add_u32 v159, 36736, v148
    v_mov_b32 v144, 0xdddddddd
    s_mul_i32 s38, s32, 3072
    s_xor_b32 s39, s32, 1
    s_mul_i32 s39, s39, 3072
    s_add_u32 s38, s38, 5248
    s_add_u32 s39, s39, 5248
    v_add_u32 v161, s38, v150
    v_add_u32 v162, s39, v150
    s_lshr_b32 s82, s32, 2
    s_mul_i32 s39, s82, 10240
    s_lshr_b32 s38, s36, 1
    s_mul_i32 s38, s38, 5120
    s_add_u32 s39, s39, s38
    s_and_b32 s38, s36, 1
    s_lshl_b32 s38, s38, 2
    s_and_b32 s87, s32, 3
    s_add_u32 s38, s38, s87
    s_lshl_b32 s83, s38, 9
    s_add_u32 s83, s83, s39
    s_lshr_b32 s38, s38, 1
    s_lshl_b32 s38, s38, 8
    s_add_u32 s84, s39, s38
    s_lshl_b32 s38, s81, 3
    s_add_u32 s84, s84, s38
    s_add_u32 s84, s84, 4096
    s_mul_i32 s38, s35, 40960
    s_add_u32 s38, s38, 3145728
    s_add_u32 s83, s83, s38
    s_add_u32 s84, s84, s38
    v_lshrrev_b32 v164, 4, v153
    v_mul_u32_u24 v164, 20480, v164
    v_lshl_add_u32 v164, v155, 4, v164
    v_lshl_add_u32 v163, v154, 8, v164
    s_and_b32 s38, s32, 3
    s_lshl_b32 s39, s33, 2
    s_add_u32 s39, s39, s38
    s_mul_i32 s85, s39, 20480
    s_add_u32 s85, s85, 3145728
    s_mul_i32 s38, s82, 10240
    s_add_u32 s85, s85, s38
    s_mul_i32 s86, s39, 20480
    s_mul_i32 s39, s34, 160
    s_add_u32 s86, s86, s39
    s_mov_b32 s88, 0

    s_mov_b32 s24, s62
    s_mov_b32 s25, s63
    s_mov_b32 s26, 2621440
    s_mov_b32 s27, 0x00020000
    s_cmp_eq_u32 s32, 4
    s_cbranch_scc1 L_rgw
    s_sub_u32 s38, s32, 5
    s_cmp_lt_u32 s38, 2
    s_cbranch_scc1 L_kvw

    s_mov_b32 s20, s42
    s_mov_b32 s21, s43
    s_mov_b32 s22, 819200
    s_mov_b32 s23, 0x00020000
    s_lshr_b32 s38, s2, 6
    s_lshl_b32 s38, s38, 1
    s_and_b32 s39, s34, 1
    s_add_u32 s38, s38, s39
    s_sub_u32 s39, s38, 5
    s_cmp_ge_u32 s38, 5
    s_cselect_b32 s38, s39, s38
    s_cselect_b32 s96, 1, 0
    s_min_u32 s78, s32, 4
    s_lshl_b32 s78, s78, 14
    s_add_u32 s78, s78, 73728
    s_lshl_b32 s73, s38, 13
    s_add_u32 s73, s73, 32768
    s_and_b32 s80, s36, 1
    s_cmp_eq_u32 s32, 7
    s_cbranch_scc1 L_qn

    s_lshl_b32 s80, s80, 6
    s_lshr_b32 s39, s32, 1
    s_lshl_b32 s39, s39, 7
    s_add_u32 s80, s80, s39
    s_mul_i32 s79, s36, 320
    s_add_u32 s79, s79, s80
    s_and_b32 s39, s32, 1
    s_mul_i32 s68, s39, 81920
    s_add_u32 s79, s79, s68
    s_lshl_b32 s39, s39, 6
    s_add_u32 s80, s80, s39
    v_lshrrev_b32 v18, 3, v145
    v_mul_u32_u24 v18, 1280, v18
    v_and_b32 v2, 7, v145
    v_and_b32 v3, 1, v156
    v_lshlrev_b32 v3, 2, v3
    v_xor_b32 v2, v2, v3
    v_lshl_add_u32 v18, v2, 4, v18

    v_add_u32 v19, 9216, v18
    v_add_u32 v20, 18432, v18
    v_add_u32 v21, 27648, v18
    s_mul_i32 s97, s96, 40960
    s_sub_u32 s98, 40960, s97
    s_mov_b32 s39, 8192
    s_mul_i32 s68, s38, 163840
    s_add_u32 s68, s68, s79
    s_add_u32 s38, s38, 1
    s_cmp_eq_u32 s38, 5
    s_cselect_b32 s38, 0, s38
    s_cselect_b32 s74, 4294934528, s39

    s_mul_i32 s69, s38, 163840
    s_add_u32 s69, s69, s79
    s_add_u32 s38, s38, 1
    s_cmp_eq_u32 s38, 5
    s_cselect_b32 s38, 0, s38
    s_cselect_b32 s75, 4294934528, s39

    s_mul_i32 s70, s38, 163840
    s_add_u32 s70, s70, s79
    s_add_u32 s38, s38, 1
    s_cmp_eq_u32 s38, 5
    s_cselect_b32 s38, 0, s38
    s_cselect_b32 s76, 4294934528, s39

    s_mul_i32 s71, s38, 163840
    s_add_u32 s71, s71, s79
    s_add_u32 s38, s38, 1
    s_cmp_eq_u32 s38, 5
    s_cselect_b32 s38, 0, s38
    s_cselect_b32 s77, 4294934528, s39

    s_mul_i32 s72, s38, 163840
    s_add_u32 s72, s72, s79
    v_and_b32 v2, 15, v153
    s_lshl_b32 s38, s96, 2
    v_xor_b32 v2, s38, v2
    v_lshlrev_b32 v3, 8, v153
    v_add_u32 v3, s73, v3

    s_and_b32 s39, s32, 1
    s_lshl_b32 s38, s39, 3
    v_add_u32 v5, s38, v154
    s_lshl_b32 s39, s39, 6

    v_add_u32 v4, 0, v5
    v_xor_b32 v4, v4, v2
    v_lshl_add_u32 v8, v4, 4, v3
    v_add_u32 v4, 2, v5
    v_xor_b32 v4, v4, v2
    v_lshl_add_u32 v9, v4, 4, v3
    v_add_u32 v4, 4, v5
    v_xor_b32 v4, v4, v2
    v_lshl_add_u32 v10, v4, 4, v3
    v_add_u32 v4, 6, v5
    v_xor_b32 v4, v4, v2
    v_lshl_add_u32 v11, v4, 4, v3
    v_lshrrev_b32 v2, 2, v155
    v_lshl_add_u32 v2, v154, 3, v2
    v_lshlrev_b32 v2, 7, v2
    v_and_b32 v3, 1, v156
    v_lshl_add_u32 v2, v3, 5, v2
    v_and_b32 v3, 3, v145
    v_lshl_add_u32 v2, v3, 3, v2
    v_lshrrev_b32 v3, 3, v155
    v_lshl_add_u32 v2, v3, 6, v2
    v_xor_b32 v2, s39, v2
    v_add_u32 v16, s78, v2
    v_xor_b32 v17, 64, v16

    s_barrier
    s_waitcnt vmcnt(0)
    v_mov_b32 v1, 163584
    v_mov_b32 v2, 1
    s_mov_b64 exec, 1
    ds_add_u32 v1, v2 offset:4
    s_mov_b64 exec, -1

    s_add_u32 m0, s90, 32768
    s_nop 0
    buffer_load_dwordx4 v7, s[16:19], s91 offen offset:0 lds
    s_add_u32 m0, s90, 40704
    s_nop 0
    buffer_load_dwordx4 v7, s[16:19], s91 offen offset:256 lds
    s_add_u32 m0, s90, 48640
    s_nop 0
    buffer_load_dwordx4 v7, s[16:19], s91 offen offset:512 lds
    s_add_u32 m0, s90, 56576
    s_nop 0
    buffer_load_dwordx4 v7, s[16:19], s91 offen offset:768 lds
    s_add_u32 m0, s90, 64512
    s_nop 0
    buffer_load_dwordx4 v7, s[16:19], s91 offen offset:1024 lds
    s_add_u32 m0, s78, 0
    s_add_u32 s79, s68, s97
    buffer_load_dwordx4 v18, s[20:23], s79 offen offset:0 lds
    buffer_load_dwordx4 v19, s[20:23], s79 offen offset:1024 lds
    buffer_load_dwordx4 v20, s[20:23], s79 offen offset:2048 lds
    buffer_load_dwordx4 v21, s[20:23], s79 offen offset:3072 lds
    s_add_u32 m0, s78, 4096
    s_add_u32 s79, s68, s98
    buffer_load_dwordx4 v18, s[20:23], s79 offen offset:0 lds
    buffer_load_dwordx4 v19, s[20:23], s79 offen offset:1024 lds
    buffer_load_dwordx4 v20, s[20:23], s79 offen offset:2048 lds
    buffer_load_dwordx4 v21, s[20:23], s79 offen offset:3072 lds
    s_waitcnt vmcnt(8)
    v_mov_b32 v1, 163584
    v_mov_b32 v2, 256
    s_mov_b64 exec, 1
    ds_add_u32 v1, v2 offset:4
    s_mov_b64 exec, -1

    v_mov_b32 v6, 163584
    v_mov_b32 v7, 256

    s_add_u32 m0, s78, 8192
    s_add_u32 s79, s69, s97
    buffer_load_dwordx4 v18, s[20:23], s79 offen offset:0 lds
    buffer_load_dwordx4 v19, s[20:23], s79 offen offset:1024 lds
    buffer_load_dwordx4 v20, s[20:23], s79 offen offset:2048 lds
    buffer_load_dwordx4 v21, s[20:23], s79 offen offset:3072 lds
    s_add_u32 m0, s78, 12288
    s_add_u32 s79, s69, s98
    buffer_load_dwordx4 v18, s[20:23], s79 offen offset:0 lds
    buffer_load_dwordx4 v19, s[20:23], s79 offen offset:1024 lds
    buffer_load_dwordx4 v20, s[20:23], s79 offen offset:2048 lds
    buffer_load_dwordx4 v21, s[20:23], s79 offen offset:3072 lds
    s_mov_b32 s39, 0
L_awqw:
    ds_read_b32 v2, v1 offset:4
    s_add_u32 s39, s39, 1
    s_cmp_gt_u32 s39, 160000
    s_waitcnt lgkmcnt(0)
    s_cbranch_scc1 L_awqw_done
    v_readfirstlane_b32 s38, v2
    s_nop 0
    s_bfe_u32 s38, s38, 0x80008
    s_cmp_eq_u32 s38, 8
    s_cbranch_scc1 L_awqw_done
    s_sleep 1
    s_branch L_awqw

L_awqw_done:
    s_waitcnt vmcnt(12)
    ds_read_b128 v[64:67], v8
    ds_read_b64_tr_b16 v[56:57], v16 offset:0
    ds_read_b64_tr_b16 v[58:59], v16 offset:512
    ds_read_b64_tr_b16 v[60:61], v17 offset:0
    ds_read_b64_tr_b16 v[62:63], v17 offset:512
    ds_read_b128 v[76:79], v9
    ds_read_b64_tr_b16 v[68:69], v16 offset:2048
    ds_read_b64_tr_b16 v[70:71], v16 offset:2560
    ds_read_b64_tr_b16 v[72:73], v17 offset:2048
    ds_read_b64_tr_b16 v[74:75], v17 offset:2560
    s_waitcnt vmcnt(8)
    ds_read_b128 v[88:91], v10
    ds_read_b64_tr_b16 v[80:81], v16 offset:4096
    ds_read_b64_tr_b16 v[82:83], v16 offset:4608
    ds_read_b64_tr_b16 v[84:85], v17 offset:4096
    ds_read_b64_tr_b16 v[86:87], v17 offset:4608
    ds_read_b128 v[100:103], v11
    ds_read_b64_tr_b16 v[92:93], v16 offset:6144
    ds_read_b64_tr_b16 v[94:95], v16 offset:6656
    ds_read_b64_tr_b16 v[96:97], v17 offset:6144
    ds_read_b64_tr_b16 v[98:99], v17 offset:6656
    s_waitcnt lgkmcnt(10)
    s_add_u32 m0, s78, 0
    s_add_u32 s79, s70, s97
    buffer_load_dwordx4 v18, s[20:23], s79 offen offset:0 lds
    buffer_load_dwordx4 v19, s[20:23], s79 offen offset:1024 lds
    buffer_load_dwordx4 v20, s[20:23], s79 offen offset:2048 lds
    buffer_load_dwordx4 v21, s[20:23], s79 offen offset:3072 lds
    s_waitcnt vmcnt(8)
    v_mfma_f32_32x32x16_bf16 v[24:39], v[56:59], v[64:67], 0
    v_add_u32 v8, s74, v8
    ds_read_b128 v[112:115], v8
    ds_read_b64_tr_b16 v[104:105], v16 offset:8192
    ds_read_b64_tr_b16 v[106:107], v16 offset:8704
    v_mfma_f32_32x32x16_bf16 v[40:55], v[60:63], v[64:67], 0
    ds_read_b64_tr_b16 v[108:109], v17 offset:8192
    ds_read_b64_tr_b16 v[110:111], v17 offset:8704
    v_mfma_f32_32x32x16_bf16 v[24:39], v[68:71], v[76:79], v[24:39]
    v_add_u32 v9, s74, v9
    ds_read_b128 v[124:127], v9
    ds_read_b64_tr_b16 v[116:117], v16 offset:10240
    ds_read_b64_tr_b16 v[118:119], v16 offset:10752
    v_mfma_f32_32x32x16_bf16 v[40:55], v[72:75], v[76:79], v[40:55]
    ds_read_b64_tr_b16 v[120:121], v17 offset:10240
    ds_read_b64_tr_b16 v[122:123], v17 offset:10752
    s_waitcnt lgkmcnt(10)
    s_add_u32 m0, s78, 4096
    s_add_u32 s79, s70, s98
    buffer_load_dwordx4 v18, s[20:23], s79 offen offset:0 lds
    buffer_load_dwordx4 v19, s[20:23], s79 offen offset:1024 lds
    buffer_load_dwordx4 v20, s[20:23], s79 offen offset:2048 lds
    buffer_load_dwordx4 v21, s[20:23], s79 offen offset:3072 lds
    s_waitcnt vmcnt(8)
    v_mfma_f32_32x32x16_bf16 v[24:39], v[80:83], v[88:91], v[24:39]
    v_add_u32 v10, s74, v10
    ds_read_b128 v[64:67], v10
    ds_read_b64_tr_b16 v[56:57], v16 offset:12288
    ds_read_b64_tr_b16 v[58:59], v16 offset:12800
    v_mfma_f32_32x32x16_bf16 v[40:55], v[84:87], v[88:91], v[40:55]
    ds_read_b64_tr_b16 v[60:61], v17 offset:12288
    ds_read_b64_tr_b16 v[62:63], v17 offset:12800
    v_mfma_f32_32x32x16_bf16 v[24:39], v[92:95], v[100:103], v[24:39]
    v_add_u32 v11, s74, v11
    ds_read_b128 v[76:79], v11
    ds_read_b64_tr_b16 v[68:69], v16 offset:14336
    ds_read_b64_tr_b16 v[70:71], v16 offset:14848
    v_mfma_f32_32x32x16_bf16 v[40:55], v[96:99], v[100:103], v[40:55]
    ds_read_b64_tr_b16 v[72:73], v17 offset:14336
    ds_read_b64_tr_b16 v[74:75], v17 offset:14848
    s_waitcnt lgkmcnt(10)
    s_add_u32 m0, s78, 8192
    s_add_u32 s79, s71, s97
    buffer_load_dwordx4 v18, s[20:23], s79 offen offset:0 lds
    buffer_load_dwordx4 v19, s[20:23], s79 offen offset:1024 lds
    buffer_load_dwordx4 v20, s[20:23], s79 offen offset:2048 lds
    buffer_load_dwordx4 v21, s[20:23], s79 offen offset:3072 lds
    s_waitcnt vmcnt(8)
    v_mfma_f32_32x32x16_bf16 v[24:39], v[104:107], v[112:115], v[24:39]
    v_add_u32 v8, s75, v8
    ds_read_b128 v[88:91], v8
    ds_read_b64_tr_b16 v[80:81], v16 offset:0
    ds_read_b64_tr_b16 v[82:83], v16 offset:512
    v_mfma_f32_32x32x16_bf16 v[40:55], v[108:111], v[112:115], v[40:55]
    ds_read_b64_tr_b16 v[84:85], v17 offset:0
    ds_read_b64_tr_b16 v[86:87], v17 offset:512
    v_mfma_f32_32x32x16_bf16 v[24:39], v[116:119], v[124:127], v[24:39]
    v_add_u32 v9, s75, v9
    ds_read_b128 v[100:103], v9
    ds_read_b64_tr_b16 v[92:93], v16 offset:2048
    ds_read_b64_tr_b16 v[94:95], v16 offset:2560
    v_mfma_f32_32x32x16_bf16 v[40:55], v[120:123], v[124:127], v[40:55]
    ds_read_b64_tr_b16 v[96:97], v17 offset:2048
    ds_read_b64_tr_b16 v[98:99], v17 offset:2560
    s_waitcnt lgkmcnt(10)
    s_add_u32 m0, s78, 12288
    s_add_u32 s79, s71, s98
    buffer_load_dwordx4 v18, s[20:23], s79 offen offset:0 lds
    buffer_load_dwordx4 v19, s[20:23], s79 offen offset:1024 lds
    buffer_load_dwordx4 v20, s[20:23], s79 offen offset:2048 lds
    buffer_load_dwordx4 v21, s[20:23], s79 offen offset:3072 lds
    s_waitcnt vmcnt(8)
    v_mfma_f32_32x32x16_bf16 v[24:39], v[56:59], v[64:67], v[24:39]
    v_add_u32 v10, s75, v10
    ds_read_b128 v[112:115], v10
    ds_read_b64_tr_b16 v[104:105], v16 offset:4096
    ds_read_b64_tr_b16 v[106:107], v16 offset:4608
    v_mfma_f32_32x32x16_bf16 v[40:55], v[60:63], v[64:67], v[40:55]
    ds_read_b64_tr_b16 v[108:109], v17 offset:4096
    ds_read_b64_tr_b16 v[110:111], v17 offset:4608
    v_mfma_f32_32x32x16_bf16 v[24:39], v[68:71], v[76:79], v[24:39]
    v_add_u32 v11, s75, v11
    ds_read_b128 v[124:127], v11
    ds_read_b64_tr_b16 v[116:117], v16 offset:6144
    ds_read_b64_tr_b16 v[118:119], v16 offset:6656
    v_mfma_f32_32x32x16_bf16 v[40:55], v[72:75], v[76:79], v[40:55]
    ds_read_b64_tr_b16 v[120:121], v17 offset:6144
    ds_read_b64_tr_b16 v[122:123], v17 offset:6656
    s_waitcnt lgkmcnt(10)
    s_add_u32 m0, s78, 0
    s_add_u32 s79, s72, s97
    buffer_load_dwordx4 v18, s[20:23], s79 offen offset:0 lds
    buffer_load_dwordx4 v19, s[20:23], s79 offen offset:1024 lds
    buffer_load_dwordx4 v20, s[20:23], s79 offen offset:2048 lds
    buffer_load_dwordx4 v21, s[20:23], s79 offen offset:3072 lds
    s_waitcnt vmcnt(8)
    v_mfma_f32_32x32x16_bf16 v[24:39], v[80:83], v[88:91], v[24:39]
    v_add_u32 v8, s76, v8
    ds_read_b128 v[64:67], v8
    ds_read_b64_tr_b16 v[56:57], v16 offset:8192
    ds_read_b64_tr_b16 v[58:59], v16 offset:8704
    v_mfma_f32_32x32x16_bf16 v[40:55], v[84:87], v[88:91], v[40:55]
    ds_read_b64_tr_b16 v[60:61], v17 offset:8192
    ds_read_b64_tr_b16 v[62:63], v17 offset:8704
    v_mfma_f32_32x32x16_bf16 v[24:39], v[92:95], v[100:103], v[24:39]
    v_add_u32 v9, s76, v9
    ds_read_b128 v[76:79], v9
    ds_read_b64_tr_b16 v[68:69], v16 offset:10240
    ds_read_b64_tr_b16 v[70:71], v16 offset:10752
    v_mfma_f32_32x32x16_bf16 v[40:55], v[96:99], v[100:103], v[40:55]
    ds_read_b64_tr_b16 v[72:73], v17 offset:10240
    ds_read_b64_tr_b16 v[74:75], v17 offset:10752
    s_waitcnt lgkmcnt(10)
    s_add_u32 m0, s78, 4096
    s_add_u32 s79, s72, s98
    buffer_load_dwordx4 v18, s[20:23], s79 offen offset:0 lds
    buffer_load_dwordx4 v19, s[20:23], s79 offen offset:1024 lds
    buffer_load_dwordx4 v20, s[20:23], s79 offen offset:2048 lds
    buffer_load_dwordx4 v21, s[20:23], s79 offen offset:3072 lds
    s_mov_b64 exec, 1
    ds_add_u32 v6, v7
    s_mov_b64 exec, -1
    s_waitcnt vmcnt(8)
    v_mfma_f32_32x32x16_bf16 v[24:39], v[104:107], v[112:115], v[24:39]
    v_add_u32 v10, s76, v10
    ds_read_b128 v[88:91], v10
    ds_read_b64_tr_b16 v[80:81], v16 offset:12288
    ds_read_b64_tr_b16 v[82:83], v16 offset:12800
    v_mfma_f32_32x32x16_bf16 v[40:55], v[108:111], v[112:115], v[40:55]
    ds_read_b64_tr_b16 v[84:85], v17 offset:12288
    ds_read_b64_tr_b16 v[86:87], v17 offset:12800
    v_mfma_f32_32x32x16_bf16 v[24:39], v[116:119], v[124:127], v[24:39]
    v_add_u32 v11, s76, v11
    ds_read_b128 v[100:103], v11
    ds_read_b64_tr_b16 v[92:93], v16 offset:14336
    ds_read_b64_tr_b16 v[94:95], v16 offset:14848
    v_mfma_f32_32x32x16_bf16 v[40:55], v[120:123], v[124:127], v[40:55]
    ds_read_b64_tr_b16 v[96:97], v17 offset:14336
    ds_read_b64_tr_b16 v[98:99], v17 offset:14848
    s_waitcnt lgkmcnt(10)
    s_waitcnt vmcnt(4)
    v_mfma_f32_32x32x16_bf16 v[24:39], v[56:59], v[64:67], v[24:39]
    v_add_u32 v8, s77, v8
    ds_read_b128 v[112:115], v8
    ds_read_b64_tr_b16 v[104:105], v16 offset:0
    ds_read_b64_tr_b16 v[106:107], v16 offset:512
    v_mfma_f32_32x32x16_bf16 v[40:55], v[60:63], v[64:67], v[40:55]
    ds_read_b64_tr_b16 v[108:109], v17 offset:0
    ds_read_b64_tr_b16 v[110:111], v17 offset:512
    v_mfma_f32_32x32x16_bf16 v[24:39], v[68:71], v[76:79], v[24:39]
    v_add_u32 v9, s77, v9
    ds_read_b128 v[124:127], v9
    ds_read_b64_tr_b16 v[116:117], v16 offset:2048
    ds_read_b64_tr_b16 v[118:119], v16 offset:2560
    v_mfma_f32_32x32x16_bf16 v[40:55], v[72:75], v[76:79], v[40:55]
    ds_read_b64_tr_b16 v[120:121], v17 offset:2048
    ds_read_b64_tr_b16 v[122:123], v17 offset:2560
    s_waitcnt lgkmcnt(10)
    s_waitcnt vmcnt(0)
    v_mfma_f32_32x32x16_bf16 v[24:39], v[80:83], v[88:91], v[24:39]
    v_add_u32 v10, s77, v10
    ds_read_b128 v[64:67], v10
    ds_read_b64_tr_b16 v[56:57], v16 offset:4096
    ds_read_b64_tr_b16 v[58:59], v16 offset:4608
    v_mfma_f32_32x32x16_bf16 v[40:55], v[84:87], v[88:91], v[40:55]
    ds_read_b64_tr_b16 v[60:61], v17 offset:4096
    ds_read_b64_tr_b16 v[62:63], v17 offset:4608
    v_mfma_f32_32x32x16_bf16 v[24:39], v[92:95], v[100:103], v[24:39]
    v_add_u32 v11, s77, v11
    ds_read_b128 v[76:79], v11
    ds_read_b64_tr_b16 v[68:69], v16 offset:6144
    ds_read_b64_tr_b16 v[70:71], v16 offset:6656
    v_mfma_f32_32x32x16_bf16 v[40:55], v[96:99], v[100:103], v[40:55]
    ds_read_b64_tr_b16 v[72:73], v17 offset:6144
    ds_read_b64_tr_b16 v[74:75], v17 offset:6656
    s_waitcnt lgkmcnt(10)
    v_mfma_f32_32x32x16_bf16 v[24:39], v[104:107], v[112:115], v[24:39]
    v_mfma_f32_32x32x16_bf16 v[40:55], v[108:111], v[112:115], v[40:55]
    v_mfma_f32_32x32x16_bf16 v[24:39], v[116:119], v[124:127], v[24:39]
    v_mfma_f32_32x32x16_bf16 v[40:55], v[120:123], v[124:127], v[40:55]
    s_waitcnt lgkmcnt(0)
    v_mfma_f32_32x32x16_bf16 v[24:39], v[56:59], v[64:67], v[24:39]
    v_mfma_f32_32x32x16_bf16 v[40:55], v[60:63], v[64:67], v[40:55]
    v_mfma_f32_32x32x16_bf16 v[24:39], v[68:71], v[76:79], v[24:39]
    v_mfma_f32_32x32x16_bf16 v[40:55], v[72:75], v[76:79], v[40:55]
    s_mov_b32 s38, 0x3ea52b5c
    v_mul_u32_u24 v1, 328, v153
    v_lshl_add_u32 v1, v154, 3, v1
    s_add_u32 s39, s80, 139264
    v_add_u32 v1, s39, v1
    v_add_u32 v2, s78, v150
    s_xor_b32 s39, s32, 1
    s_lshl_b32 s39, s39, 14
    s_add_u32 s39, s39, 73728
    v_add_u32 v3, s39, v150
    s_nop 2

    ds_write_b128 v2, v[40:43] offset:0
    ds_write_b128 v2, v[44:47] offset:1024
    ds_write_b128 v2, v[48:51] offset:2048
    ds_write_b128 v2, v[52:55] offset:3072
    v_mov_b32 v112, 0
    v_mov_b32 v113, 0
    v_mov_b32 v114, 0
    v_mov_b32 v115, 0
    v_mov_b32 v116, 0
    v_mov_b32 v117, 0
    v_mov_b32 v118, 0
    v_mov_b32 v119, 0
    v_mov_b32 v120, 0
    v_mov_b32 v121, 0
    v_mov_b32 v122, 0
    v_mov_b32 v123, 0
    v_mov_b32 v124, 0
    v_mov_b32 v125, 0
    v_mov_b32 v126, 0
    v_mov_b32 v127, 0
    v_mov_b32 v128, 0
    v_mov_b32 v129, 0
    v_mov_b32 v130, 0
    v_mov_b32 v131, 0
    v_mov_b32 v132, 0
    v_mov_b32 v133, 0
    v_mov_b32 v134, 0
    v_mov_b32 v135, 0
    v_mov_b32 v136, 0
    v_mov_b32 v137, 0
    v_mov_b32 v138, 0
    v_mov_b32 v139, 0
    v_mov_b32 v140, 0
    v_mov_b32 v141, 0
    v_mov_b32 v142, 0
    v_mov_b32 v143, 0
    v_mov_b32 v104, 0
    v_mov_b32 v105, 0
    v_mov_b32 v106, 0
    v_mov_b32 v107, 0
    v_mov_b32 v108, 0
    v_mov_b32 v109, 0
    v_mov_b32 v110, 0
    v_mov_b32 v111, 0
    s_waitcnt lgkmcnt(0)
    s_barrier
    ds_read_b128 v[40:43], v3 offset:0
    ds_read_b128 v[44:47], v3 offset:1024
    ds_read_b128 v[48:51], v3 offset:2048
    ds_read_b128 v[52:55], v3 offset:3072
    s_waitcnt lgkmcnt(3)
    v_add_f32 v24, v24, v40
    v_add_f32 v25, v25, v41
    v_add_f32 v26, v26, v42
    v_add_f32 v27, v27, v43
    s_waitcnt lgkmcnt(2)
    v_add_f32 v28, v28, v44
    v_add_f32 v29, v29, v45
    v_add_f32 v30, v30, v46
    v_add_f32 v31, v31, v47
    s_waitcnt lgkmcnt(1)
    v_add_f32 v32, v32, v48
    v_add_f32 v33, v33, v49
    v_add_f32 v34, v34, v50
    v_add_f32 v35, v35, v51
    s_waitcnt lgkmcnt(0)
    v_add_f32 v36, v36, v52
    v_add_f32 v37, v37, v53
    v_add_f32 v38, v38, v54
    v_add_f32 v39, v39, v55
    v_mul_f32 v24, s38, v24
    v_mul_f32 v25, s38, v25
    v_mul_f32 v26, s38, v26
    v_mul_f32 v27, s38, v27
    v_mul_f32 v28, s38, v28
    v_mul_f32 v29, s38, v29
    v_mul_f32 v30, s38, v30
    v_mul_f32 v31, s38, v31
    v_mul_f32 v32, s38, v32
    v_mul_f32 v33, s38, v33
    v_mul_f32 v34, s38, v34
    v_mul_f32 v35, s38, v35
    v_mul_f32 v36, s38, v36
    v_mul_f32 v37, s38, v37
    v_mul_f32 v38, s38, v38
    v_mul_f32 v39, s38, v39
    v_cvt_pk_bf16_f32 v80, v24, v25
    v_cvt_pk_bf16_f32 v81, v26, v27
    ds_write_b64 v1, v[80:81] offset:0
    v_cvt_pk_bf16_f32 v82, v28, v29
    v_cvt_pk_bf16_f32 v83, v30, v31
    ds_write_b64 v1, v[82:83] offset:16
    v_cvt_pk_bf16_f32 v84, v32, v33
    v_cvt_pk_bf16_f32 v85, v34, v35
    ds_write_b64 v1, v[84:85] offset:32
    v_cvt_pk_bf16_f32 v86, v36, v37
    v_cvt_pk_bf16_f32 v87, v38, v39
    ds_write_b64 v1, v[86:87] offset:48
    s_branch L_f2
L_qn:
    s_setprio 1
    s_xor_b32 s80, s80, 1
    s_lshl_b32 s80, s80, 8
    s_mul_i32 s79, s36, 320
    s_add_u32 s79, s79, s80
    v_lshrrev_b32 v18, 2, v145
    v_mul_u32_u24 v18, 1280, v18
    v_and_b32 v2, 3, v145
    v_lshl_add_u32 v18, v2, 4, v18

    v_add_u32 v19, 19456, v18
    v_add_u32 v20, 38912, v18
    v_add_u32 v21, 58368, v18
    s_mul_i32 s97, s96, 81920
    s_sub_u32 s98, 81920, s97
    s_mov_b32 s39, 8192
    s_mul_i32 s68, s38, 163840
    s_add_u32 s68, s68, s79
    s_add_u32 s38, s38, 1
    s_cmp_eq_u32 s38, 5
    s_cselect_b32 s38, 0, s38
    s_cselect_b32 s74, 4294934528, s39

    s_mul_i32 s69, s38, 163840
    s_add_u32 s69, s69, s79
    s_add_u32 s38, s38, 1
    s_cmp_eq_u32 s38, 5
    s_cselect_b32 s38, 0, s38
    s_cselect_b32 s75, 4294934528, s39

    s_mul_i32 s70, s38, 163840
    s_add_u32 s70, s70, s79
    s_add_u32 s38, s38, 1
    s_cmp_eq_u32 s38, 5
    s_cselect_b32 s38, 0, s38
    s_cselect_b32 s76, 4294934528, s39

    s_mul_i32 s71, s38, 163840
    s_add_u32 s71, s71, s79
    s_add_u32 s38, s38, 1
    s_cmp_eq_u32 s38, 5
    s_cselect_b32 s38, 0, s38
    s_cselect_b32 s77, 4294934528, s39

    s_mul_i32 s72, s38, 163840
    s_add_u32 s72, s72, s79
    v_and_b32 v2, 15, v153
    s_lshl_b32 s38, s96, 3
    v_xor_b32 v2, s38, v2
    v_lshlrev_b32 v3, 8, v153
    v_add_u32 v3, s73, v3

    v_add_u32 v4, 0, v154
    v_xor_b32 v4, v4, v2
    v_lshl_add_u32 v8, v4, 4, v3
    v_add_u32 v4, 2, v154
    v_xor_b32 v4, v4, v2
    v_lshl_add_u32 v9, v4, 4, v3
    v_add_u32 v4, 4, v154
    v_xor_b32 v4, v4, v2
    v_lshl_add_u32 v10, v4, 4, v3
    v_add_u32 v4, 6, v154
    v_xor_b32 v4, v4, v2
    v_lshl_add_u32 v11, v4, 4, v3
    v_add_u32 v4, 8, v154
    v_xor_b32 v4, v4, v2
    v_lshl_add_u32 v12, v4, 4, v3
    v_add_u32 v4, 10, v154
    v_xor_b32 v4, v4, v2
    v_lshl_add_u32 v13, v4, 4, v3
    v_add_u32 v4, 12, v154
    v_xor_b32 v4, v4, v2
    v_lshl_add_u32 v14, v4, 4, v3
    v_add_u32 v4, 14, v154
    v_xor_b32 v4, v4, v2
    v_lshl_add_u32 v15, v4, 4, v3
    v_lshrrev_b32 v2, 2, v155
    v_lshl_add_u32 v2, v154, 3, v2
    v_lshlrev_b32 v2, 6, v2
    v_and_b32 v3, 1, v156
    v_lshl_add_u32 v2, v3, 5, v2
    v_and_b32 v3, 3, v145
    v_lshl_add_u32 v2, v3, 3, v2
    v_add_u32 v16, s78, v2

    s_barrier
    s_waitcnt vmcnt(0)
    v_mov_b32 v1, 163584
    v_mov_b32 v2, 257
    s_mov_b64 exec, 1
    ds_add_u32 v1, v2 offset:4
    s_mov_b64 exec, -1

    s_add_u32 m0, s78, 0
    s_add_u32 s79, s68, s97
    buffer_load_dwordx4 v18, s[20:23], s79 offen offset:0 lds
    buffer_load_dwordx4 v19, s[20:23], s79 offen offset:1024 lds
    buffer_load_dwordx4 v20, s[20:23], s79 offen offset:2048 lds
    buffer_load_dwordx4 v21, s[20:23], s79 offen offset:3072 lds
    s_add_u32 m0, s78, 4096
    s_add_u32 s79, s68, s98
    buffer_load_dwordx4 v18, s[20:23], s79 offen offset:0 lds
    buffer_load_dwordx4 v19, s[20:23], s79 offen offset:1024 lds
    buffer_load_dwordx4 v20, s[20:23], s79 offen offset:2048 lds
    buffer_load_dwordx4 v21, s[20:23], s79 offen offset:3072 lds
    v_mov_b32 v6, 163584
    v_mov_b32 v7, 256

    s_add_u32 m0, s78, 8192
    s_add_u32 s79, s69, s97
    buffer_load_dwordx4 v18, s[20:23], s79 offen offset:0 lds
    buffer_load_dwordx4 v19, s[20:23], s79 offen offset:1024 lds
    buffer_load_dwordx4 v20, s[20:23], s79 offen offset:2048 lds
    buffer_load_dwordx4 v21, s[20:23], s79 offen offset:3072 lds
    s_add_u32 m0, s78, 12288
    s_add_u32 s79, s69, s98
    buffer_load_dwordx4 v18, s[20:23], s79 offen offset:0 lds
    buffer_load_dwordx4 v19, s[20:23], s79 offen offset:1024 lds
    buffer_load_dwordx4 v20, s[20:23], s79 offen offset:2048 lds
    buffer_load_dwordx4 v21, s[20:23], s79 offen offset:3072 lds
    s_mov_b32 s39, 0
L_awqn:
    ds_read_b32 v2, v1 offset:4
    s_add_u32 s39, s39, 1
    s_cmp_gt_u32 s39, 160000
    s_waitcnt lgkmcnt(0)
    s_cbranch_scc1 L_awqn_done
    v_readfirstlane_b32 s38, v2
    s_nop 0
    s_bfe_u32 s38, s38, 0x80008
    s_cmp_eq_u32 s38, 8
    s_cbranch_scc1 L_awqn_done
    s_sleep 1
    s_branch L_awqn

L_awqn_done:
    s_waitcnt vmcnt(12)
    ds_read_b64_tr_b16 v[40:41], v16 offset:0
    ds_read_b64_tr_b16 v[42:43], v16 offset:256
    ds_read_b128 v[44:47], v8
    ds_read_b64_tr_b16 v[48:49], v16 offset:1024
    ds_read_b64_tr_b16 v[50:51], v16 offset:1280
    ds_read_b128 v[52:55], v9
    ds_read_b64_tr_b16 v[56:57], v16 offset:2048
    ds_read_b64_tr_b16 v[58:59], v16 offset:2304
    ds_read_b128 v[60:63], v10
    ds_read_b64_tr_b16 v[64:65], v16 offset:3072
    ds_read_b64_tr_b16 v[66:67], v16 offset:3328
    ds_read_b128 v[68:71], v11
    s_waitcnt vmcnt(8)
    ds_read_b64_tr_b16 v[72:73], v16 offset:4096
    ds_read_b64_tr_b16 v[74:75], v16 offset:4352
    ds_read_b128 v[76:79], v12
    ds_read_b64_tr_b16 v[80:81], v16 offset:5120
    ds_read_b64_tr_b16 v[82:83], v16 offset:5376
    ds_read_b128 v[84:87], v13
    ds_read_b64_tr_b16 v[88:89], v16 offset:6144
    ds_read_b64_tr_b16 v[90:91], v16 offset:6400
    ds_read_b128 v[92:95], v14
    ds_read_b64_tr_b16 v[96:97], v16 offset:7168
    ds_read_b64_tr_b16 v[98:99], v16 offset:7424
    ds_read_b128 v[100:103], v15
    s_waitcnt lgkmcnt(12)
    s_add_u32 m0, s78, 0
    s_add_u32 s79, s70, s97
    buffer_load_dwordx4 v18, s[20:23], s79 offen offset:0 lds
    buffer_load_dwordx4 v19, s[20:23], s79 offen offset:1024 lds
    buffer_load_dwordx4 v20, s[20:23], s79 offen offset:2048 lds
    buffer_load_dwordx4 v21, s[20:23], s79 offen offset:3072 lds
    s_waitcnt vmcnt(8)
    v_mfma_f32_32x32x16_bf16 v[24:39], v[40:43], v[44:47], 0
    v_add_u32 v8, s74, v8
    ds_read_b64_tr_b16 v[104:105], v16 offset:8192
    ds_read_b64_tr_b16 v[106:107], v16 offset:8448
    ds_read_b128 v[108:111], v8
    v_mfma_f32_32x32x16_bf16 v[24:39], v[48:51], v[52:55], v[24:39]
    v_add_u32 v9, s74, v9
    ds_read_b64_tr_b16 v[112:113], v16 offset:9216
    ds_read_b64_tr_b16 v[114:115], v16 offset:9472
    ds_read_b128 v[116:119], v9
    v_mfma_f32_32x32x16_bf16 v[24:39], v[56:59], v[60:63], v[24:39]
    v_add_u32 v10, s74, v10
    ds_read_b64_tr_b16 v[120:121], v16 offset:10240
    ds_read_b64_tr_b16 v[122:123], v16 offset:10496
    ds_read_b128 v[124:127], v10
    v_mfma_f32_32x32x16_bf16 v[24:39], v[64:67], v[68:71], v[24:39]
    v_add_u32 v11, s74, v11
    ds_read_b64_tr_b16 v[128:129], v16 offset:11264
    ds_read_b64_tr_b16 v[130:131], v16 offset:11520
    ds_read_b128 v[132:135], v11
    s_waitcnt lgkmcnt(12)
    s_add_u32 m0, s78, 4096
    s_add_u32 s79, s70, s98
    buffer_load_dwordx4 v18, s[20:23], s79 offen offset:0 lds
    buffer_load_dwordx4 v19, s[20:23], s79 offen offset:1024 lds
    buffer_load_dwordx4 v20, s[20:23], s79 offen offset:2048 lds
    buffer_load_dwordx4 v21, s[20:23], s79 offen offset:3072 lds
    s_waitcnt vmcnt(8)
    v_mfma_f32_32x32x16_bf16 v[24:39], v[72:75], v[76:79], v[24:39]
    v_add_u32 v12, s74, v12
    ds_read_b64_tr_b16 v[40:41], v16 offset:12288
    ds_read_b64_tr_b16 v[42:43], v16 offset:12544
    ds_read_b128 v[44:47], v12
    v_mfma_f32_32x32x16_bf16 v[24:39], v[80:83], v[84:87], v[24:39]
    v_add_u32 v13, s74, v13
    ds_read_b64_tr_b16 v[48:49], v16 offset:13312
    ds_read_b64_tr_b16 v[50:51], v16 offset:13568
    ds_read_b128 v[52:55], v13
    v_mfma_f32_32x32x16_bf16 v[24:39], v[88:91], v[92:95], v[24:39]
    v_add_u32 v14, s74, v14
    ds_read_b64_tr_b16 v[56:57], v16 offset:14336
    ds_read_b64_tr_b16 v[58:59], v16 offset:14592
    ds_read_b128 v[60:63], v14
    v_mfma_f32_32x32x16_bf16 v[24:39], v[96:99], v[100:103], v[24:39]
    v_add_u32 v15, s74, v15
    ds_read_b64_tr_b16 v[64:65], v16 offset:15360
    ds_read_b64_tr_b16 v[66:67], v16 offset:15616
    ds_read_b128 v[68:71], v15
    s_waitcnt lgkmcnt(12)
    s_add_u32 m0, s78, 8192
    s_add_u32 s79, s71, s97
    buffer_load_dwordx4 v18, s[20:23], s79 offen offset:0 lds
    buffer_load_dwordx4 v19, s[20:23], s79 offen offset:1024 lds
    buffer_load_dwordx4 v20, s[20:23], s79 offen offset:2048 lds
    buffer_load_dwordx4 v21, s[20:23], s79 offen offset:3072 lds
    s_waitcnt vmcnt(8)
    v_mfma_f32_32x32x16_bf16 v[24:39], v[104:107], v[108:111], v[24:39]
    v_add_u32 v8, s75, v8
    ds_read_b64_tr_b16 v[72:73], v16 offset:0
    ds_read_b64_tr_b16 v[74:75], v16 offset:256
    ds_read_b128 v[76:79], v8
    v_mfma_f32_32x32x16_bf16 v[24:39], v[112:115], v[116:119], v[24:39]
    v_add_u32 v9, s75, v9
    ds_read_b64_tr_b16 v[80:81], v16 offset:1024
    ds_read_b64_tr_b16 v[82:83], v16 offset:1280
    ds_read_b128 v[84:87], v9
    v_mfma_f32_32x32x16_bf16 v[24:39], v[120:123], v[124:127], v[24:39]
    v_add_u32 v10, s75, v10
    ds_read_b64_tr_b16 v[88:89], v16 offset:2048
    ds_read_b64_tr_b16 v[90:91], v16 offset:2304
    ds_read_b128 v[92:95], v10
    v_mfma_f32_32x32x16_bf16 v[24:39], v[128:131], v[132:135], v[24:39]
    v_add_u32 v11, s75, v11
    ds_read_b64_tr_b16 v[96:97], v16 offset:3072
    ds_read_b64_tr_b16 v[98:99], v16 offset:3328
    ds_read_b128 v[100:103], v11
    s_waitcnt lgkmcnt(12)
    s_add_u32 m0, s78, 12288
    s_add_u32 s79, s71, s98
    buffer_load_dwordx4 v18, s[20:23], s79 offen offset:0 lds
    buffer_load_dwordx4 v19, s[20:23], s79 offen offset:1024 lds
    buffer_load_dwordx4 v20, s[20:23], s79 offen offset:2048 lds
    buffer_load_dwordx4 v21, s[20:23], s79 offen offset:3072 lds
    s_waitcnt vmcnt(8)
    v_mfma_f32_32x32x16_bf16 v[24:39], v[40:43], v[44:47], v[24:39]
    v_add_u32 v12, s75, v12
    ds_read_b64_tr_b16 v[104:105], v16 offset:4096
    ds_read_b64_tr_b16 v[106:107], v16 offset:4352
    ds_read_b128 v[108:111], v12
    v_mfma_f32_32x32x16_bf16 v[24:39], v[48:51], v[52:55], v[24:39]
    v_add_u32 v13, s75, v13
    ds_read_b64_tr_b16 v[112:113], v16 offset:5120
    ds_read_b64_tr_b16 v[114:115], v16 offset:5376
    ds_read_b128 v[116:119], v13
    v_mfma_f32_32x32x16_bf16 v[24:39], v[56:59], v[60:63], v[24:39]
    v_add_u32 v14, s75, v14
    ds_read_b64_tr_b16 v[120:121], v16 offset:6144
    ds_read_b64_tr_b16 v[122:123], v16 offset:6400
    ds_read_b128 v[124:127], v14
    v_mfma_f32_32x32x16_bf16 v[24:39], v[64:67], v[68:71], v[24:39]
    v_add_u32 v15, s75, v15
    ds_read_b64_tr_b16 v[128:129], v16 offset:7168
    ds_read_b64_tr_b16 v[130:131], v16 offset:7424
    ds_read_b128 v[132:135], v15
    s_waitcnt lgkmcnt(12)
    s_add_u32 m0, s78, 0
    s_add_u32 s79, s72, s97
    buffer_load_dwordx4 v18, s[20:23], s79 offen offset:0 lds
    buffer_load_dwordx4 v19, s[20:23], s79 offen offset:1024 lds
    buffer_load_dwordx4 v20, s[20:23], s79 offen offset:2048 lds
    buffer_load_dwordx4 v21, s[20:23], s79 offen offset:3072 lds
    s_waitcnt vmcnt(8)
    v_mfma_f32_32x32x16_bf16 v[24:39], v[72:75], v[76:79], v[24:39]
    v_add_u32 v8, s76, v8
    ds_read_b64_tr_b16 v[40:41], v16 offset:8192
    ds_read_b64_tr_b16 v[42:43], v16 offset:8448
    ds_read_b128 v[44:47], v8
    v_mfma_f32_32x32x16_bf16 v[24:39], v[80:83], v[84:87], v[24:39]
    v_add_u32 v9, s76, v9
    ds_read_b64_tr_b16 v[48:49], v16 offset:9216
    ds_read_b64_tr_b16 v[50:51], v16 offset:9472
    ds_read_b128 v[52:55], v9
    v_mfma_f32_32x32x16_bf16 v[24:39], v[88:91], v[92:95], v[24:39]
    v_add_u32 v10, s76, v10
    ds_read_b64_tr_b16 v[56:57], v16 offset:10240
    ds_read_b64_tr_b16 v[58:59], v16 offset:10496
    ds_read_b128 v[60:63], v10
    v_mfma_f32_32x32x16_bf16 v[24:39], v[96:99], v[100:103], v[24:39]
    v_add_u32 v11, s76, v11
    ds_read_b64_tr_b16 v[64:65], v16 offset:11264
    ds_read_b64_tr_b16 v[66:67], v16 offset:11520
    ds_read_b128 v[68:71], v11
    s_waitcnt lgkmcnt(12)
    s_add_u32 m0, s78, 4096
    s_add_u32 s79, s72, s98
    buffer_load_dwordx4 v18, s[20:23], s79 offen offset:0 lds
    buffer_load_dwordx4 v19, s[20:23], s79 offen offset:1024 lds
    buffer_load_dwordx4 v20, s[20:23], s79 offen offset:2048 lds
    buffer_load_dwordx4 v21, s[20:23], s79 offen offset:3072 lds
    s_mov_b64 exec, 1
    ds_add_u32 v6, v7
    s_mov_b64 exec, -1
    s_waitcnt vmcnt(8)
    v_mfma_f32_32x32x16_bf16 v[24:39], v[104:107], v[108:111], v[24:39]
    v_add_u32 v12, s76, v12
    ds_read_b64_tr_b16 v[72:73], v16 offset:12288
    ds_read_b64_tr_b16 v[74:75], v16 offset:12544
    ds_read_b128 v[76:79], v12
    v_mfma_f32_32x32x16_bf16 v[24:39], v[112:115], v[116:119], v[24:39]
    v_add_u32 v13, s76, v13
    ds_read_b64_tr_b16 v[80:81], v16 offset:13312
    ds_read_b64_tr_b16 v[82:83], v16 offset:13568
    ds_read_b128 v[84:87], v13
    v_mfma_f32_32x32x16_bf16 v[24:39], v[120:123], v[124:127], v[24:39]
    v_add_u32 v14, s76, v14
    ds_read_b64_tr_b16 v[88:89], v16 offset:14336
    ds_read_b64_tr_b16 v[90:91], v16 offset:14592
    ds_read_b128 v[92:95], v14
    v_mfma_f32_32x32x16_bf16 v[24:39], v[128:131], v[132:135], v[24:39]
    v_add_u32 v15, s76, v15
    ds_read_b64_tr_b16 v[96:97], v16 offset:15360
    ds_read_b64_tr_b16 v[98:99], v16 offset:15616
    ds_read_b128 v[100:103], v15
    s_waitcnt lgkmcnt(12)
    s_waitcnt vmcnt(4)
    v_mfma_f32_32x32x16_bf16 v[24:39], v[40:43], v[44:47], v[24:39]
    v_add_u32 v8, s77, v8
    ds_read_b64_tr_b16 v[104:105], v16 offset:0
    ds_read_b64_tr_b16 v[106:107], v16 offset:256
    ds_read_b128 v[108:111], v8
    v_mfma_f32_32x32x16_bf16 v[24:39], v[48:51], v[52:55], v[24:39]
    v_add_u32 v9, s77, v9
    ds_read_b64_tr_b16 v[112:113], v16 offset:1024
    ds_read_b64_tr_b16 v[114:115], v16 offset:1280
    ds_read_b128 v[116:119], v9
    v_mfma_f32_32x32x16_bf16 v[24:39], v[56:59], v[60:63], v[24:39]
    v_add_u32 v10, s77, v10
    ds_read_b64_tr_b16 v[120:121], v16 offset:2048
    ds_read_b64_tr_b16 v[122:123], v16 offset:2304
    ds_read_b128 v[124:127], v10
    v_mfma_f32_32x32x16_bf16 v[24:39], v[64:67], v[68:71], v[24:39]
    v_add_u32 v11, s77, v11
    ds_read_b64_tr_b16 v[128:129], v16 offset:3072
    ds_read_b64_tr_b16 v[130:131], v16 offset:3328
    ds_read_b128 v[132:135], v11
    s_waitcnt lgkmcnt(12)
    s_waitcnt vmcnt(0)
    v_mfma_f32_32x32x16_bf16 v[24:39], v[72:75], v[76:79], v[24:39]
    v_add_u32 v12, s77, v12
    ds_read_b64_tr_b16 v[40:41], v16 offset:4096
    ds_read_b64_tr_b16 v[42:43], v16 offset:4352
    ds_read_b128 v[44:47], v12
    v_mfma_f32_32x32x16_bf16 v[24:39], v[80:83], v[84:87], v[24:39]
    v_add_u32 v13, s77, v13
    ds_read_b64_tr_b16 v[48:49], v16 offset:5120
    ds_read_b64_tr_b16 v[50:51], v16 offset:5376
    ds_read_b128 v[52:55], v13
    v_mfma_f32_32x32x16_bf16 v[24:39], v[88:91], v[92:95], v[24:39]
    v_add_u32 v14, s77, v14
    ds_read_b64_tr_b16 v[56:57], v16 offset:6144
    ds_read_b64_tr_b16 v[58:59], v16 offset:6400
    ds_read_b128 v[60:63], v14
    v_mfma_f32_32x32x16_bf16 v[24:39], v[96:99], v[100:103], v[24:39]
    v_add_u32 v15, s77, v15
    ds_read_b64_tr_b16 v[64:65], v16 offset:7168
    ds_read_b64_tr_b16 v[66:67], v16 offset:7424
    ds_read_b128 v[68:71], v15
    s_waitcnt lgkmcnt(12)
    v_mfma_f32_32x32x16_bf16 v[24:39], v[104:107], v[108:111], v[24:39]
    v_mfma_f32_32x32x16_bf16 v[24:39], v[112:115], v[116:119], v[24:39]
    v_mfma_f32_32x32x16_bf16 v[24:39], v[120:123], v[124:127], v[24:39]
    v_mfma_f32_32x32x16_bf16 v[24:39], v[128:131], v[132:135], v[24:39]
    s_waitcnt lgkmcnt(0)
    v_mfma_f32_32x32x16_bf16 v[24:39], v[40:43], v[44:47], v[24:39]
    v_mfma_f32_32x32x16_bf16 v[24:39], v[48:51], v[52:55], v[24:39]
    v_mfma_f32_32x32x16_bf16 v[24:39], v[56:59], v[60:63], v[24:39]
    v_mfma_f32_32x32x16_bf16 v[24:39], v[64:67], v[68:71], v[24:39]
    s_mov_b32 s38, 0x3ea52b5c
    v_mul_u32_u24 v1, 328, v153
    v_lshl_add_u32 v1, v154, 3, v1
    s_add_u32 s39, s80, 139264
    v_add_u32 v1, s39, v1
    v_add_u32 v2, s78, v150
    s_xor_b32 s39, s32, 1
    s_lshl_b32 s39, s39, 14
    s_add_u32 s39, s39, 73728
    v_add_u32 v3, s39, v150
    s_nop 2

    v_mul_f32 v24, s38, v24
    v_mul_f32 v25, s38, v25
    v_mul_f32 v26, s38, v26
    v_mul_f32 v27, s38, v27
    v_mul_f32 v28, s38, v28
    v_mul_f32 v29, s38, v29
    v_mul_f32 v30, s38, v30
    v_mul_f32 v31, s38, v31
    v_mul_f32 v32, s38, v32
    v_mul_f32 v33, s38, v33
    v_mul_f32 v34, s38, v34
    v_mul_f32 v35, s38, v35
    v_mul_f32 v36, s38, v36
    v_mul_f32 v37, s38, v37
    v_mul_f32 v38, s38, v38
    v_mul_f32 v39, s38, v39
    v_cvt_pk_bf16_f32 v72, v24, v25
    v_cvt_pk_bf16_f32 v73, v26, v27
    ds_write_b64 v1, v[72:73] offset:0
    v_cvt_pk_bf16_f32 v74, v28, v29
    v_cvt_pk_bf16_f32 v75, v30, v31
    ds_write_b64 v1, v[74:75] offset:16
    v_cvt_pk_bf16_f32 v76, v32, v33
    v_cvt_pk_bf16_f32 v77, v34, v35
    ds_write_b64 v1, v[76:77] offset:32
    v_cvt_pk_bf16_f32 v78, v36, v37
    v_cvt_pk_bf16_f32 v79, v38, v39
    ds_write_b64 v1, v[78:79] offset:48
    s_branch L_f2a
L_kvw:
    s_setprio 3
    s_and_b32 s38, s36, 1
    s_lshl_b32 s38, s38, 12
    s_add_u32 s38, s38, 32768
    v_lshlrev_b32 v3, 8, v155
    v_add_u32 v3, s38, v3

    v_add_u32 v4, 0, v156
    v_xor_b32 v4, v4, v155
    v_lshl_add_u32 v8, v4, 4, v3
    v_add_u32 v4, 4, v156
    v_xor_b32 v4, v4, v155
    v_lshl_add_u32 v9, v4, 4, v3
    v_add_u32 v4, 8, v156
    v_xor_b32 v4, v4, v155
    v_lshl_add_u32 v10, v4, 4, v3
    v_add_u32 v4, 12, v156
    v_xor_b32 v4, v4, v155
    v_lshl_add_u32 v11, v4, 4, v3
    v_lshrrev_b32 v1, 2, v155
    v_lshl_add_u32 v1, v156, 3, v1
    v_mul_u32_u24 v1, 40, v1
    v_and_b32 v2, 3, v145
    v_lshl_add_u32 v1, v2, 3, v1
    s_sub_u32 s38, s32, 5
    s_lshl_b32 s38, s38, 5
    s_add_u32 s38, s38, 0
    v_add_u32 v16, s38, v1
    s_lshl_b32 s38, s37, 5
    s_lshl_b32 s39, s32, 3
    s_add_u32 s38, s38, s39
    s_add_u32 s38, s38, 7667672
    v_mov_b32 v115, s38

    s_mov_b32 s12, s64
    s_mov_b32 s13, s65
    s_mov_b32 s14, 256
    s_mov_b32 s15, 0x00020000
    v_mov_b32 v114, 0
    s_barrier
    s_waitcnt vmcnt(0)
    v_mov_b32 v1, 163584
    v_mov_b32 v2, 257
    s_mov_b64 exec, 1
    ds_add_u32 v1, v2 offset:4
    s_mov_b64 exec, -1

    buffer_load_dwordx2 v[112:113], v114, s[12:15], 0 offen sc1
    s_mov_b32 s39, 0
L_awkv:
    ds_read_b32 v2, v1 offset:4
    s_add_u32 s39, s39, 1
    s_cmp_gt_u32 s39, 160000
    s_waitcnt lgkmcnt(0)
    s_cbranch_scc1 L_awkv_done
    v_readfirstlane_b32 s38, v2
    s_nop 0
    s_bfe_u32 s38, s38, 0x80000
    s_cmp_eq_u32 s38, 9
    s_cbranch_scc1 L_awkv_done
    s_sleep 1
    s_branch L_awkv

L_awkv_done:
    s_mul_i32 s68, s35, 2624
    s_add_u32 s68, s68, 6291456
    s_and_b32 s69, s36, 1
    s_cmp_ge_u32 s36, 2
    s_cbranch_scc1 L_vw

    ds_read_b64_tr_b16 v[28:29], v16 offset:0
    ds_read_b64_tr_b16 v[30:31], v16 offset:160
    ds_read_b128 v[32:35], v8 offset:0
    ds_read_b64_tr_b16 v[36:37], v16 offset:1280
    ds_read_b64_tr_b16 v[38:39], v16 offset:1440
    ds_read_b128 v[40:43], v9 offset:0
    ds_read_b64_tr_b16 v[44:45], v16 offset:2560
    ds_read_b64_tr_b16 v[46:47], v16 offset:2720
    ds_read_b128 v[48:51], v10 offset:0
    ds_read_b64_tr_b16 v[52:53], v16 offset:3840
    ds_read_b64_tr_b16 v[54:55], v16 offset:4000
    ds_read_b128 v[56:59], v11 offset:0
    ds_read_b64_tr_b16 v[60:61], v16 offset:5120
    ds_read_b64_tr_b16 v[62:63], v16 offset:5280
    ds_read_b128 v[64:67], v8 offset:8192
    s_waitcnt lgkmcnt(0)
    ds_read_b64_tr_b16 v[68:69], v16 offset:6400
    ds_read_b64_tr_b16 v[70:71], v16 offset:6560
    ds_read_b128 v[72:75], v9 offset:8192
    ds_read_b64_tr_b16 v[76:77], v16 offset:7680
    ds_read_b64_tr_b16 v[78:79], v16 offset:7840
    ds_read_b128 v[80:83], v10 offset:8192
    ds_read_b64_tr_b16 v[84:85], v16 offset:8960
    ds_read_b64_tr_b16 v[86:87], v16 offset:9120
    ds_read_b128 v[88:91], v11 offset:8192
    ds_read_b64_tr_b16 v[92:93], v16 offset:10240
    ds_read_b64_tr_b16 v[94:95], v16 offset:10400
    ds_read_b128 v[96:99], v8 offset:16384
    ds_read_b64_tr_b16 v[100:101], v16 offset:11520
    ds_read_b64_tr_b16 v[102:103], v16 offset:11680
    ds_read_b128 v[104:107], v9 offset:16384
    v_mfma_f32_16x16x32_bf16 v[20:23], v[28:31], v[32:35], 0
    v_mfma_f32_16x16x32_bf16 v[20:23], v[36:39], v[40:43], v[20:23]
    v_mfma_f32_16x16x32_bf16 v[20:23], v[44:47], v[48:51], v[20:23]
    v_mfma_f32_16x16x32_bf16 v[20:23], v[52:55], v[56:59], v[20:23]
    v_mfma_f32_16x16x32_bf16 v[20:23], v[60:63], v[64:67], v[20:23]
    s_waitcnt lgkmcnt(0)
    ds_read_b64_tr_b16 v[28:29], v16 offset:12800
    ds_read_b64_tr_b16 v[30:31], v16 offset:12960
    ds_read_b128 v[32:35], v10 offset:16384
    ds_read_b64_tr_b16 v[36:37], v16 offset:14080
    ds_read_b64_tr_b16 v[38:39], v16 offset:14240
    ds_read_b128 v[40:43], v11 offset:16384
    ds_read_b64_tr_b16 v[44:45], v16 offset:15360
    ds_read_b64_tr_b16 v[46:47], v16 offset:15520
    ds_read_b128 v[48:51], v8 offset:24576
    ds_read_b64_tr_b16 v[52:53], v16 offset:16640
    ds_read_b64_tr_b16 v[54:55], v16 offset:16800
    ds_read_b128 v[56:59], v9 offset:24576
    ds_read_b64_tr_b16 v[60:61], v16 offset:17920
    ds_read_b64_tr_b16 v[62:63], v16 offset:18080
    ds_read_b128 v[64:67], v10 offset:24576
    v_mfma_f32_16x16x32_bf16 v[20:23], v[68:71], v[72:75], v[20:23]
    v_mfma_f32_16x16x32_bf16 v[20:23], v[76:79], v[80:83], v[20:23]
    v_mfma_f32_16x16x32_bf16 v[20:23], v[84:87], v[88:91], v[20:23]
    v_mfma_f32_16x16x32_bf16 v[20:23], v[92:95], v[96:99], v[20:23]
    v_mfma_f32_16x16x32_bf16 v[20:23], v[100:103], v[104:107], v[20:23]
    s_waitcnt lgkmcnt(0)
    ds_read_b64_tr_b16 v[68:69], v16 offset:19200
    ds_read_b64_tr_b16 v[70:71], v16 offset:19360
    ds_read_b128 v[72:75], v11 offset:24576
    ds_read_b64_tr_b16 v[76:77], v16 offset:20480
    ds_read_b64_tr_b16 v[78:79], v16 offset:20640
    ds_read_b128 v[80:83], v8 offset:32768
    ds_read_b64_tr_b16 v[84:85], v16 offset:21760
    ds_read_b64_tr_b16 v[86:87], v16 offset:21920
    ds_read_b128 v[88:91], v9 offset:32768
    ds_read_b64_tr_b16 v[92:93], v16 offset:23040
    ds_read_b64_tr_b16 v[94:95], v16 offset:23200
    ds_read_b128 v[96:99], v10 offset:32768
    ds_read_b64_tr_b16 v[100:101], v16 offset:24320
    ds_read_b64_tr_b16 v[102:103], v16 offset:24480
    ds_read_b128 v[104:107], v11 offset:32768
    v_mfma_f32_16x16x32_bf16 v[20:23], v[28:31], v[32:35], v[20:23]
    v_mfma_f32_16x16x32_bf16 v[20:23], v[36:39], v[40:43], v[20:23]
    v_mfma_f32_16x16x32_bf16 v[20:23], v[44:47], v[48:51], v[20:23]
    v_mfma_f32_16x16x32_bf16 v[20:23], v[52:55], v[56:59], v[20:23]
    v_mfma_f32_16x16x32_bf16 v[20:23], v[60:63], v[64:67], v[20:23]
    s_waitcnt lgkmcnt(0)
    v_mfma_f32_16x16x32_bf16 v[20:23], v[68:71], v[72:75], v[20:23]
    v_mfma_f32_16x16x32_bf16 v[20:23], v[76:79], v[80:83], v[20:23]
    v_mfma_f32_16x16x32_bf16 v[20:23], v[84:87], v[88:91], v[20:23]
    v_mfma_f32_16x16x32_bf16 v[20:23], v[92:95], v[96:99], v[20:23]
    v_mfma_f32_16x16x32_bf16 v[20:23], v[100:103], v[104:107], v[20:23]
    s_lshl_b32 s39, s69, 4
    v_add_u32 v1, s39, v155
    v_lshl_add_u32 v3, v154, 5, v1
    v_lshlrev_b32 v3, 4, v3
    v_and_b32 v2, 1, v156
    v_lshl_add_u32 v3, v2, 3, v3
    v_lshlrev_b32 v4, 2, v1
    s_nop 1
    v_cvt_pk_bf16_f32 v28, v20, v21
    v_cvt_pk_bf16_f32 v29, v22, v23
    s_cmp_eq_u32 s32, 6
    s_cbranch_scc1 L_k2
    buffer_store_dwordx2 v[28:29], v3, s[8:11], s68 offen sc1
    s_branch L_pub

L_k2:
    s_mov_b64 exec, 0xffff
    buffer_store_dword v28, v4, s[8:11], s68 offen offset:1024 sc1
    buffer_store_dword v29, v4, s[8:11], s68 offen offset:1152 sc1
    s_mov_b64 exec, -1
    s_branch L_pub

L_vw:
    ds_read_b64_tr_b16 v[28:29], v16 offset:0
    ds_read_b64_tr_b16 v[30:31], v16 offset:160
    ds_read_b128 v[32:35], v8 offset:0
    ds_read_b64_tr_b16 v[36:37], v16 offset:1280
    ds_read_b64_tr_b16 v[38:39], v16 offset:1440
    ds_read_b128 v[40:43], v9 offset:0
    ds_read_b64_tr_b16 v[44:45], v16 offset:2560
    ds_read_b64_tr_b16 v[46:47], v16 offset:2720
    ds_read_b128 v[48:51], v10 offset:0
    ds_read_b64_tr_b16 v[52:53], v16 offset:3840
    ds_read_b64_tr_b16 v[54:55], v16 offset:4000
    ds_read_b128 v[56:59], v11 offset:0
    ds_read_b64_tr_b16 v[60:61], v16 offset:5120
    ds_read_b64_tr_b16 v[62:63], v16 offset:5280
    ds_read_b128 v[64:67], v8 offset:8192
    s_waitcnt lgkmcnt(0)
    ds_read_b64_tr_b16 v[68:69], v16 offset:6400
    ds_read_b64_tr_b16 v[70:71], v16 offset:6560
    ds_read_b128 v[72:75], v9 offset:8192
    ds_read_b64_tr_b16 v[76:77], v16 offset:7680
    ds_read_b64_tr_b16 v[78:79], v16 offset:7840
    ds_read_b128 v[80:83], v10 offset:8192
    ds_read_b64_tr_b16 v[84:85], v16 offset:8960
    ds_read_b64_tr_b16 v[86:87], v16 offset:9120
    ds_read_b128 v[88:91], v11 offset:8192
    ds_read_b64_tr_b16 v[92:93], v16 offset:10240
    ds_read_b64_tr_b16 v[94:95], v16 offset:10400
    ds_read_b128 v[96:99], v8 offset:16384
    ds_read_b64_tr_b16 v[100:101], v16 offset:11520
    ds_read_b64_tr_b16 v[102:103], v16 offset:11680
    ds_read_b128 v[104:107], v9 offset:16384
    v_mfma_f32_16x16x32_bf16 v[20:23], v[32:35], v[28:31], 0
    v_mfma_f32_16x16x32_bf16 v[20:23], v[40:43], v[36:39], v[20:23]
    v_mfma_f32_16x16x32_bf16 v[20:23], v[48:51], v[44:47], v[20:23]
    v_mfma_f32_16x16x32_bf16 v[20:23], v[56:59], v[52:55], v[20:23]
    v_mfma_f32_16x16x32_bf16 v[20:23], v[64:67], v[60:63], v[20:23]
    s_waitcnt lgkmcnt(0)
    ds_read_b64_tr_b16 v[28:29], v16 offset:12800
    ds_read_b64_tr_b16 v[30:31], v16 offset:12960
    ds_read_b128 v[32:35], v10 offset:16384
    ds_read_b64_tr_b16 v[36:37], v16 offset:14080
    ds_read_b64_tr_b16 v[38:39], v16 offset:14240
    ds_read_b128 v[40:43], v11 offset:16384
    ds_read_b64_tr_b16 v[44:45], v16 offset:15360
    ds_read_b64_tr_b16 v[46:47], v16 offset:15520
    ds_read_b128 v[48:51], v8 offset:24576
    ds_read_b64_tr_b16 v[52:53], v16 offset:16640
    ds_read_b64_tr_b16 v[54:55], v16 offset:16800
    ds_read_b128 v[56:59], v9 offset:24576
    ds_read_b64_tr_b16 v[60:61], v16 offset:17920
    ds_read_b64_tr_b16 v[62:63], v16 offset:18080
    ds_read_b128 v[64:67], v10 offset:24576
    v_mfma_f32_16x16x32_bf16 v[20:23], v[72:75], v[68:71], v[20:23]
    v_mfma_f32_16x16x32_bf16 v[20:23], v[80:83], v[76:79], v[20:23]
    v_mfma_f32_16x16x32_bf16 v[20:23], v[88:91], v[84:87], v[20:23]
    v_mfma_f32_16x16x32_bf16 v[20:23], v[96:99], v[92:95], v[20:23]
    v_mfma_f32_16x16x32_bf16 v[20:23], v[104:107], v[100:103], v[20:23]
    s_waitcnt lgkmcnt(0)
    ds_read_b64_tr_b16 v[68:69], v16 offset:19200
    ds_read_b64_tr_b16 v[70:71], v16 offset:19360
    ds_read_b128 v[72:75], v11 offset:24576
    ds_read_b64_tr_b16 v[76:77], v16 offset:20480
    ds_read_b64_tr_b16 v[78:79], v16 offset:20640
    ds_read_b128 v[80:83], v8 offset:32768
    ds_read_b64_tr_b16 v[84:85], v16 offset:21760
    ds_read_b64_tr_b16 v[86:87], v16 offset:21920
    ds_read_b128 v[88:91], v9 offset:32768
    ds_read_b64_tr_b16 v[92:93], v16 offset:23040
    ds_read_b64_tr_b16 v[94:95], v16 offset:23200
    ds_read_b128 v[96:99], v10 offset:32768
    ds_read_b64_tr_b16 v[100:101], v16 offset:24320
    ds_read_b64_tr_b16 v[102:103], v16 offset:24480
    ds_read_b128 v[104:107], v11 offset:32768
    v_mfma_f32_16x16x32_bf16 v[20:23], v[32:35], v[28:31], v[20:23]
    v_mfma_f32_16x16x32_bf16 v[20:23], v[40:43], v[36:39], v[20:23]
    v_mfma_f32_16x16x32_bf16 v[20:23], v[48:51], v[44:47], v[20:23]
    v_mfma_f32_16x16x32_bf16 v[20:23], v[56:59], v[52:55], v[20:23]
    v_mfma_f32_16x16x32_bf16 v[20:23], v[64:67], v[60:63], v[20:23]
    s_waitcnt lgkmcnt(0)
    v_mfma_f32_16x16x32_bf16 v[20:23], v[72:75], v[68:71], v[20:23]
    v_mfma_f32_16x16x32_bf16 v[20:23], v[80:83], v[76:79], v[20:23]
    v_mfma_f32_16x16x32_bf16 v[20:23], v[88:91], v[84:87], v[20:23]
    v_mfma_f32_16x16x32_bf16 v[20:23], v[96:99], v[92:95], v[20:23]
    v_mfma_f32_16x16x32_bf16 v[20:23], v[104:107], v[100:103], v[20:23]
    s_mul_i32 s39, s69, 672
    s_add_u32 s68, s68, s39
    v_mul_u32_u24 v3, 336, v154
    v_lshl_add_u32 v3, v155, 4, v3
    v_and_b32 v2, 1, v156
    v_lshl_add_u32 v3, v2, 3, v3
    v_mov_b32 v5, 0x3f803f80
    v_cmp_eq_u32 vcc, 4, v155
    v_cvt_pk_bf16_f32 v28, v20, v21
    v_cvt_pk_bf16_f32 v29, v22, v23
    s_cmp_eq_u32 s32, 6
    s_cbranch_scc1 L_v2
    buffer_store_dwordx2 v[28:29], v3, s[8:11], s68 offen offset:1280 sc1
    s_branch L_pub

L_v2:
    v_cndmask_b32 v28, v28, v5, vcc
    v_cndmask_b32 v29, v29, v5, vcc
    v_cmp_gt_u32 vcc, 5, v155
    s_and_saveexec_b64 s[6:7], vcc
    buffer_store_dwordx2 v[28:29], v3, s[8:11], s68 offen offset:1536 sc1
    s_mov_b64 exec, -1
    s_branch L_pub

L_rgw:
    s_barrier
    s_waitcnt vmcnt(0)
    v_mov_b32 v1, 163584
    v_mov_b32 v2, 257
    s_mov_b64 exec, 1
    ds_add_u32 v1, v2 offset:4
    s_mov_b64 exec, -1

    s_cmp_lg_u32 s36, 0
    s_cbranch_scc1 L_rg_none

    s_mov_b32 s28, s52
    s_mov_b32 s29, s53
    s_mov_b32 s30, 1280
    s_mov_b32 s31, 0x00020000
    s_mov_b32 m0, 155648
    s_nop 0
    buffer_load_dwordx4 v150, s[28:31], 0 offen offset:0 lds
    s_mov_b32 m0, 155648
    s_nop 0
    buffer_load_dwordx4 v150, s[28:31], 0 offen offset:1024 lds
    s_mov_b32 s28, s60
    s_mov_b32 s29, s61
    s_mov_b32 s30, 1280
    s_mov_b32 s31, 0x00020000
    s_mov_b32 m0, 157696
    s_nop 0
    buffer_load_dwordx4 v150, s[28:31], 0 offen offset:0 lds
    s_mov_b32 m0, 157696
    s_nop 0
    buffer_load_dwordx4 v150, s[28:31], 0 offen offset:1024 lds
    v_lshlrev_b32 v3, 8, v155
    v_add_u32 v3, 32768, v3
    v_add_u32 v4, 0, v156
    v_xor_b32 v4, v4, v155
    v_lshl_add_u32 v8, v4, 4, v3
    v_add_u32 v4, 4, v156
    v_xor_b32 v4, v4, v155
    v_lshl_add_u32 v9, v4, 4, v3
    v_add_u32 v4, 8, v156
    v_xor_b32 v4, v4, v155
    v_lshl_add_u32 v10, v4, 4, v3
    v_add_u32 v4, 12, v156
    v_xor_b32 v4, v4, v155
    v_lshl_add_u32 v11, v4, 4, v3
    v_cmp_eq_u32 vcc, 1, v155
    v_mov_b32 v1, 155648
    v_mov_b32 v2, 157696
    v_cndmask_b32 v1, v1, v2, vcc
    v_lshl_add_u32 v16, v156, 4, v1

    v_mov_b32 v1, 163584
    s_mov_b32 s39, 0
L_awrg:
    ds_read_b32 v2, v1 offset:4
    s_add_u32 s39, s39, 1
    s_cmp_gt_u32 s39, 160000
    s_waitcnt lgkmcnt(0)
    s_cbranch_scc1 L_awrg_done
    v_readfirstlane_b32 s38, v2
    s_nop 0
    s_bfe_u32 s38, s38, 0x80008
    s_cmp_eq_u32 s38, 8
    s_cbranch_scc1 L_awrg_done
    s_sleep 1
    s_branch L_awrg

L_awrg_done:
    s_waitcnt vmcnt(0)
    ds_read_b128 v[28:31], v16 offset:0
    ds_read_b128 v[32:35], v8 offset:0
    ds_read_b128 v[36:39], v8 offset:4096
    ds_read_b128 v[40:43], v16 offset:64
    ds_read_b128 v[44:47], v9 offset:0
    ds_read_b128 v[48:51], v9 offset:4096
    ds_read_b128 v[52:55], v16 offset:128
    ds_read_b128 v[56:59], v10 offset:0
    ds_read_b128 v[60:63], v10 offset:4096
    ds_read_b128 v[64:67], v16 offset:192
    ds_read_b128 v[68:71], v11 offset:0
    ds_read_b128 v[72:75], v11 offset:4096
    s_waitcnt lgkmcnt(0)
    ds_read_b128 v[76:79], v16 offset:256
    ds_read_b128 v[80:83], v8 offset:8192
    ds_read_b128 v[84:87], v8 offset:12288
    ds_read_b128 v[88:91], v16 offset:320
    ds_read_b128 v[92:95], v9 offset:8192
    ds_read_b128 v[96:99], v9 offset:12288
    ds_read_b128 v[100:103], v16 offset:384
    ds_read_b128 v[104:107], v10 offset:8192
    ds_read_b128 v[108:111], v10 offset:12288
    ds_read_b128 v[112:115], v16 offset:448
    ds_read_b128 v[116:119], v11 offset:8192
    ds_read_b128 v[120:123], v11 offset:12288
    v_mfma_f32_16x16x32_bf16 v[20:23], v[28:31], v[32:35], 0
    v_mfma_f32_16x16x32_bf16 v[24:27], v[28:31], v[36:39], 0
    v_mfma_f32_16x16x32_bf16 v[20:23], v[40:43], v[44:47], v[20:23]
    v_mfma_f32_16x16x32_bf16 v[24:27], v[40:43], v[48:51], v[24:27]
    v_mfma_f32_16x16x32_bf16 v[20:23], v[52:55], v[56:59], v[20:23]
    v_mfma_f32_16x16x32_bf16 v[24:27], v[52:55], v[60:63], v[24:27]
    v_mfma_f32_16x16x32_bf16 v[20:23], v[64:67], v[68:71], v[20:23]
    v_mfma_f32_16x16x32_bf16 v[24:27], v[64:67], v[72:75], v[24:27]
    s_waitcnt lgkmcnt(0)
    ds_read_b128 v[28:31], v16 offset:512
    ds_read_b128 v[32:35], v8 offset:16384
    ds_read_b128 v[36:39], v8 offset:20480
    ds_read_b128 v[40:43], v16 offset:576
    ds_read_b128 v[44:47], v9 offset:16384
    ds_read_b128 v[48:51], v9 offset:20480
    ds_read_b128 v[52:55], v16 offset:640
    ds_read_b128 v[56:59], v10 offset:16384
    ds_read_b128 v[60:63], v10 offset:20480
    ds_read_b128 v[64:67], v16 offset:704
    ds_read_b128 v[68:71], v11 offset:16384
    ds_read_b128 v[72:75], v11 offset:20480
    v_mfma_f32_16x16x32_bf16 v[20:23], v[76:79], v[80:83], v[20:23]
    v_mfma_f32_16x16x32_bf16 v[24:27], v[76:79], v[84:87], v[24:27]
    v_mfma_f32_16x16x32_bf16 v[20:23], v[88:91], v[92:95], v[20:23]
    v_mfma_f32_16x16x32_bf16 v[24:27], v[88:91], v[96:99], v[24:27]
    v_mfma_f32_16x16x32_bf16 v[20:23], v[100:103], v[104:107], v[20:23]
    v_mfma_f32_16x16x32_bf16 v[24:27], v[100:103], v[108:111], v[24:27]
    v_mfma_f32_16x16x32_bf16 v[20:23], v[112:115], v[116:119], v[20:23]
    v_mfma_f32_16x16x32_bf16 v[24:27], v[112:115], v[120:123], v[24:27]
    s_waitcnt lgkmcnt(0)
    ds_read_b128 v[76:79], v16 offset:768
    ds_read_b128 v[80:83], v8 offset:24576
    ds_read_b128 v[84:87], v8 offset:28672
    ds_read_b128 v[88:91], v16 offset:832
    ds_read_b128 v[92:95], v9 offset:24576
    ds_read_b128 v[96:99], v9 offset:28672
    ds_read_b128 v[100:103], v16 offset:896
    ds_read_b128 v[104:107], v10 offset:24576
    ds_read_b128 v[108:111], v10 offset:28672
    ds_read_b128 v[112:115], v16 offset:960
    ds_read_b128 v[116:119], v11 offset:24576
    ds_read_b128 v[120:123], v11 offset:28672
    v_mfma_f32_16x16x32_bf16 v[20:23], v[28:31], v[32:35], v[20:23]
    v_mfma_f32_16x16x32_bf16 v[24:27], v[28:31], v[36:39], v[24:27]
    v_mfma_f32_16x16x32_bf16 v[20:23], v[40:43], v[44:47], v[20:23]
    v_mfma_f32_16x16x32_bf16 v[24:27], v[40:43], v[48:51], v[24:27]
    v_mfma_f32_16x16x32_bf16 v[20:23], v[52:55], v[56:59], v[20:23]
    v_mfma_f32_16x16x32_bf16 v[24:27], v[52:55], v[60:63], v[24:27]
    v_mfma_f32_16x16x32_bf16 v[20:23], v[64:67], v[68:71], v[20:23]
    v_mfma_f32_16x16x32_bf16 v[24:27], v[64:67], v[72:75], v[24:27]
    s_waitcnt lgkmcnt(0)
    ds_read_b128 v[28:31], v16 offset:1024
    ds_read_b128 v[32:35], v8 offset:32768
    ds_read_b128 v[36:39], v8 offset:36864
    ds_read_b128 v[40:43], v16 offset:1088
    ds_read_b128 v[44:47], v9 offset:32768
    ds_read_b128 v[48:51], v9 offset:36864
    ds_read_b128 v[52:55], v16 offset:1152
    ds_read_b128 v[56:59], v10 offset:32768
    ds_read_b128 v[60:63], v10 offset:36864
    ds_read_b128 v[64:67], v16 offset:1216
    ds_read_b128 v[68:71], v11 offset:32768
    ds_read_b128 v[72:75], v11 offset:36864
    v_mfma_f32_16x16x32_bf16 v[20:23], v[76:79], v[80:83], v[20:23]
    v_mfma_f32_16x16x32_bf16 v[24:27], v[76:79], v[84:87], v[24:27]
    v_mfma_f32_16x16x32_bf16 v[20:23], v[88:91], v[92:95], v[20:23]
    v_mfma_f32_16x16x32_bf16 v[24:27], v[88:91], v[96:99], v[24:27]
    v_mfma_f32_16x16x32_bf16 v[20:23], v[100:103], v[104:107], v[20:23]
    v_mfma_f32_16x16x32_bf16 v[24:27], v[100:103], v[108:111], v[24:27]
    v_mfma_f32_16x16x32_bf16 v[20:23], v[112:115], v[116:119], v[20:23]
    v_mfma_f32_16x16x32_bf16 v[24:27], v[112:115], v[120:123], v[24:27]
    s_waitcnt lgkmcnt(0)
    v_mfma_f32_16x16x32_bf16 v[20:23], v[28:31], v[32:35], v[20:23]
    v_mfma_f32_16x16x32_bf16 v[24:27], v[28:31], v[36:39], v[24:27]
    v_mfma_f32_16x16x32_bf16 v[20:23], v[40:43], v[44:47], v[20:23]
    v_mfma_f32_16x16x32_bf16 v[24:27], v[40:43], v[48:51], v[24:27]
    v_mfma_f32_16x16x32_bf16 v[20:23], v[52:55], v[56:59], v[20:23]
    v_mfma_f32_16x16x32_bf16 v[24:27], v[52:55], v[60:63], v[24:27]
    v_mfma_f32_16x16x32_bf16 v[20:23], v[64:67], v[68:71], v[20:23]
    v_mfma_f32_16x16x32_bf16 v[24:27], v[64:67], v[72:75], v[24:27]
    s_lshl_b32 s38, s35, 5
    v_add_u32 v1, s38, v155
    v_sub_u32 v2, 2047, v1
    v_lshlrev_b32 v1, 2, v1
    s_mov_b32 s39, 7340032
    s_lshl_b32 s38, s35, 3
    s_add_u32 s38, s38, 7405568
    v_mov_b32 v5, 0
    s_nop 1

    v_ashrrev_i32 v3, 31, v20
    v_or_b32 v3, 0x80000000, v3
    v_xor_b32 v3, v3, v20
    v_and_b32 v3, 0xfffff800, v3
    v_or_b32 v3, v3, v2
    v_cvt_pk_bf16_f32 v4, v21, v21
    v_subrev_u32 v2, 16, v2
    v_max_u32_dpp v3, v3, v3 row_shr:1 row_mask:0xf bank_mask:0xf
    v_and_b32 v4, 0xffff0000, v4
    v_mul_f32 v4, 0xbfb8aa3b, v4
    v_max_u32_dpp v3, v3, v3 row_shr:2 row_mask:0xf bank_mask:0xf
    v_exp_f32 v4, v4
    s_nop 0
    v_max_u32_dpp v3, v3, v3 row_shr:4 row_mask:0xf bank_mask:0xf
    v_add_f32 v4, 1.0, v4
    v_rcp_f32 v4, v4
    v_max_u32_dpp v3, v3, v3 row_shr:8 row_mask:0xf bank_mask:0xf
    v_cvt_pk_bf16_f32 v4, v4, v4
    v_and_b32 v4, 0xffff0000, v4
    s_mov_b64 exec, 0xffff
    buffer_store_dword v4, v1, s[8:11], s39 offen offset:0 sc1
    s_mov_b64 exec, 0x8000
    buffer_store_dword v3, v5, s[8:11], s38 offen offset:0 sc1
    s_mov_b64 exec, -1

    v_ashrrev_i32 v3, 31, v24
    v_or_b32 v3, 0x80000000, v3
    v_xor_b32 v3, v3, v24
    v_and_b32 v3, 0xfffff800, v3
    v_or_b32 v3, v3, v2
    v_cvt_pk_bf16_f32 v4, v25, v25
    v_subrev_u32 v2, 16, v2
    v_max_u32_dpp v3, v3, v3 row_shr:1 row_mask:0xf bank_mask:0xf
    v_and_b32 v4, 0xffff0000, v4
    v_mul_f32 v4, 0xbfb8aa3b, v4
    v_max_u32_dpp v3, v3, v3 row_shr:2 row_mask:0xf bank_mask:0xf
    v_exp_f32 v4, v4
    s_nop 0
    v_max_u32_dpp v3, v3, v3 row_shr:4 row_mask:0xf bank_mask:0xf
    v_add_f32 v4, 1.0, v4
    v_rcp_f32 v4, v4
    v_max_u32_dpp v3, v3, v3 row_shr:8 row_mask:0xf bank_mask:0xf
    v_cvt_pk_bf16_f32 v4, v4, v4
    v_and_b32 v4, 0xffff0000, v4
    s_mov_b64 exec, 0xffff
    buffer_store_dword v4, v1, s[8:11], s39 offen offset:64 sc1
    s_mov_b64 exec, 0x8000
    buffer_store_dword v3, v5, s[8:11], s38 offen offset:4 sc1
    s_mov_b64 exec, -1

    s_waitcnt vmcnt(0)
    s_setprio 0
    s_branch L_f2a
L_pub:
    v_mov_b32 v1, 163584
    v_mov_b32 v2, 1
    s_mov_b64 exec, 1
    ds_add_u32 v1, v2
    s_mov_b32 s38, 0
    s_waitcnt vmcnt(0)
    v_cmp_eq_u32 vcc, 0, v112
    s_cbranch_vccz L_pub_go

L_pub_tag:
    buffer_load_dwordx2 v[112:113], v114, s[12:15], 0 offen sc1
    s_add_u32 s38, s38, 1
    s_cmp_gt_u32 s38, 20000
    s_waitcnt vmcnt(0)
    s_cbranch_scc1 L_pub_go
    v_cmp_eq_u32 vcc, 0, v112
    s_cbranch_vccnz L_pub_tag

L_pub_go:
    buffer_store_dwordx2 v[112:113], v115, s[8:11], 0 offen sc1
    s_mov_b64 exec, -1
    s_setprio 0
    s_branch L_f2a

L_rg_none:
L_f2a:
    s_setprio 0
    v_mov_b32 v112, 0
    v_mov_b32 v113, 0
    v_mov_b32 v114, 0
    v_mov_b32 v115, 0
    v_mov_b32 v116, 0
    v_mov_b32 v117, 0
    v_mov_b32 v118, 0
    v_mov_b32 v119, 0
    v_mov_b32 v120, 0
    v_mov_b32 v121, 0
    v_mov_b32 v122, 0
    v_mov_b32 v123, 0
    v_mov_b32 v124, 0
    v_mov_b32 v125, 0
    v_mov_b32 v126, 0
    v_mov_b32 v127, 0
    v_mov_b32 v128, 0
    v_mov_b32 v129, 0
    v_mov_b32 v130, 0
    v_mov_b32 v131, 0
    v_mov_b32 v132, 0
    v_mov_b32 v133, 0
    v_mov_b32 v134, 0
    v_mov_b32 v135, 0
    v_mov_b32 v136, 0
    v_mov_b32 v137, 0
    v_mov_b32 v138, 0
    v_mov_b32 v139, 0
    v_mov_b32 v140, 0
    v_mov_b32 v141, 0
    v_mov_b32 v142, 0
    v_mov_b32 v143, 0
    v_mov_b32 v104, 0
    v_mov_b32 v105, 0
    v_mov_b32 v106, 0
    v_mov_b32 v107, 0
    v_mov_b32 v108, 0
    v_mov_b32 v109, 0
    v_mov_b32 v110, 0
    v_mov_b32 v111, 0
    s_barrier
L_f2:
    s_waitcnt lgkmcnt(0)
    s_barrier

    s_setprio 1
    ds_read2_b64 v[8:11], v149 offset0:0 offset1:1
    ds_read_b32 v16, v165 offset:32
    ds_read_b128 v[36:39], v150 offset:0
    ds_read_b32 v44, v151 offset:1024
    ds_read2_b64 v[12:15], v166 offset0:0 offset1:1
    ds_read_b32 v18, v167 offset:32
    ds_read_b128 v[20:23], v146 offset:0
    ds_read_b32 v28, v147 offset:1024
    ds_read_b128 v[32:35], v148 offset:1280
    ds_read_b128 v[40:43], v148 offset:1952
    ds_read_b128 v[24:27], v146 offset:5248
    ds_read_b32 v30, v147 offset:6272
    v_mov_b32 v45, 0
    v_mov_b32 v17, 0
    v_mov_b32 v19, 0
    v_mov_b32 v29, 0x3f803f80
    v_mov_b32 v31, 0x3f803f80

    s_waitcnt lgkmcnt(8)
    v_mfma_f32_32x32x8_bf16 v[64:79], v[44:45], v[16:17], 0
    v_mfma_f32_32x32x16_bf16 v[64:79], v[36:39], v[8:11], v[64:79]
    s_waitcnt lgkmcnt(6)
    v_mfma_f32_32x32x8_bf16 v[80:95], v[44:45], v[18:19], 0
    v_mfma_f32_32x32x16_bf16 v[80:95], v[36:39], v[12:15], v[80:95]
    s_nop 8
    v_max3_f32 v149, v64, v65, v66
    v_max3_f32 v149, v149, v67, v68
    v_max3_f32 v149, v149, v69, v70
    v_max3_f32 v149, v149, v71, v72
    v_max3_f32 v149, v149, v73, v74
    v_max3_f32 v149, v149, v75, v76
    v_max3_f32 v149, v149, v77, v78
    v_max_f32 v149, v149, v79
    v_xor_b32 v149, 0x80000000, v149
    v_lshrrev_b32 v1, 16, v149
    v_cndmask_b32 v17, 0, v1, s[4:5]

    s_mov_b32 s39, 41984
    s_waitcnt lgkmcnt(4)
    v_mfma_f32_32x32x8_bf16 v[48:63], v[28:29], v[16:17], 0
    v_mfma_f32_32x32x16_bf16 v[48:63], v[20:23], v[8:11], v[48:63]
    v_max3_f32 v149, v80, v81, v82
    v_max3_f32 v149, v149, v83, v84
    v_max3_f32 v149, v149, v85, v86
    v_max3_f32 v149, v149, v87, v88
    v_max3_f32 v149, v149, v89, v90
    v_max3_f32 v149, v149, v91, v92
    v_max3_f32 v149, v149, v93, v94
    v_max_f32 v149, v149, v95
    v_xor_b32 v149, 0x80000000, v149
    v_lshrrev_b32 v1, 16, v149
    v_cndmask_b32 v19, 0, v1, s[4:5]

    v_mov_b32 v44, 0
    v_mov_b32 v45, 0
    v_mov_b32 v46, 0
    v_mov_b32 v47, 0
.p2align 6
L_loop:
    v_exp_f32 v48, v48
    v_exp_f32 v49, v49
    v_mfma_f32_32x32x8_bf16 v[64:79], v[28:29], v[18:19], 0
    v_exp_f32 v50, v50
    v_exp_f32 v51, v51
    v_exp_f32 v52, v52
    v_exp_f32 v53, v53
    v_mfma_f32_32x32x16_bf16 v[64:79], v[20:23], v[12:15], v[64:79]
    v_exp_f32 v54, v54
    v_exp_f32 v55, v55
    v_exp_f32 v56, v56
    v_exp_f32 v57, v57
    v_smfmac_f32_32x32x32_bf16 v[128:143], v[44:47], v[104:111], v144
    s_waitcnt lgkmcnt(0)
    ds_read_b128 v[44:47], v148 offset:7200
    v_exp_f32 v58, v58
    v_exp_f32 v59, v59
    v_exp_f32 v60, v60
    v_exp_f32 v61, v61
    v_smfmac_f32_32x32x32_bf16 v[112:127], v[32:35], v[48:55], v144
    ds_read_b128 v[36:39], v148 offset:6528
    v_exp_f32 v62, v62
    v_exp_f32 v63, v63
    v_exp_f32 v64, v64
    v_exp_f32 v65, v65
    v_mfma_f32_32x32x8_bf16 v[80:95], v[30:31], v[16:17], 0
    v_exp_f32 v66, v66
    v_exp_f32 v67, v67
    v_exp_f32 v68, v68
    v_exp_f32 v69, v69
    v_mfma_f32_32x32x16_bf16 v[80:95], v[24:27], v[8:11], v[80:95]
    v_exp_f32 v70, v70
    v_exp_f32 v71, v71
    v_exp_f32 v72, v72
    v_exp_f32 v73, v73
    v_smfmac_f32_32x32x32_bf16 v[112:127], v[40:43], v[56:63], v144
    s_waitcnt lgkmcnt(0)
    ds_read_b128 v[20:23], v146 offset:10496
    v_exp_f32 v74, v74
    v_exp_f32 v75, v75
    v_exp_f32 v76, v76
    v_exp_f32 v77, v77
    v_smfmac_f32_32x32x32_bf16 v[128:143], v[32:35], v[64:71], v144
    ds_read_b32 v28, v147 offset:11520
    v_exp_f32 v78, v78
    v_exp_f32 v79, v79
    v_exp_f32 v80, v80
    v_exp_f32 v81, v81
    v_mfma_f32_32x32x8_bf16 v[96:111], v[30:31], v[18:19], 0
    v_exp_f32 v82, v82
    v_exp_f32 v83, v83
    v_exp_f32 v84, v84
    v_exp_f32 v85, v85
    v_mfma_f32_32x32x16_bf16 v[96:111], v[24:27], v[12:15], v[96:111]
    v_exp_f32 v86, v86
    v_exp_f32 v87, v87
    v_exp_f32 v88, v88
    v_exp_f32 v89, v89
    v_smfmac_f32_32x32x32_bf16 v[128:143], v[40:43], v[72:79], v144
    s_waitcnt lgkmcnt(0)
    ds_read_b128 v[40:43], v148 offset:12448
    v_exp_f32 v90, v90
    v_exp_f32 v91, v91
    v_exp_f32 v92, v92
    v_exp_f32 v93, v93
    v_smfmac_f32_32x32x32_bf16 v[112:127], v[36:39], v[80:87], v144
    ds_read_b128 v[32:35], v148 offset:11776
    v_exp_f32 v94, v94
    v_exp_f32 v95, v95
    v_exp_f32 v96, v96
    v_exp_f32 v97, v97
    v_mfma_f32_32x32x8_bf16 v[48:63], v[28:29], v[16:17], 0
    v_exp_f32 v98, v98
    v_exp_f32 v99, v99
    v_exp_f32 v100, v100
    v_exp_f32 v101, v101
    v_mfma_f32_32x32x16_bf16 v[48:63], v[20:23], v[8:11], v[48:63]
    v_exp_f32 v102, v102
    v_exp_f32 v103, v103
    v_exp_f32 v104, v104
    v_exp_f32 v105, v105
    v_smfmac_f32_32x32x32_bf16 v[112:127], v[44:47], v[88:95], v144
    s_waitcnt lgkmcnt(0)
    ds_read_b128 v[24:27], v146 offset:15744
    v_exp_f32 v106, v106
    v_exp_f32 v107, v107
    v_exp_f32 v108, v108
    v_exp_f32 v109, v109
    v_smfmac_f32_32x32x32_bf16 v[128:143], v[36:39], v[96:103], v144
    ds_read_b32 v30, v147 offset:16768
    v_exp_f32 v110, v110
    v_exp_f32 v111, v111
    v_exp_f32 v48, v48
    v_exp_f32 v49, v49
    v_mfma_f32_32x32x8_bf16 v[64:79], v[28:29], v[18:19], 0
    v_exp_f32 v50, v50
    v_exp_f32 v51, v51
    v_exp_f32 v52, v52
    v_exp_f32 v53, v53
    v_mfma_f32_32x32x16_bf16 v[64:79], v[20:23], v[12:15], v[64:79]
    v_exp_f32 v54, v54
    v_exp_f32 v55, v55
    v_exp_f32 v56, v56
    v_exp_f32 v57, v57
    v_smfmac_f32_32x32x32_bf16 v[128:143], v[44:47], v[104:111], v144
    s_waitcnt lgkmcnt(0)
    ds_read_b128 v[44:47], v148 offset:17696
    v_exp_f32 v58, v58
    v_exp_f32 v59, v59
    v_exp_f32 v60, v60
    v_exp_f32 v61, v61
    v_smfmac_f32_32x32x32_bf16 v[112:127], v[32:35], v[48:55], v144
    ds_read_b128 v[36:39], v148 offset:17024
    v_exp_f32 v62, v62
    v_exp_f32 v63, v63
    v_exp_f32 v64, v64
    v_exp_f32 v65, v65
    v_mfma_f32_32x32x8_bf16 v[80:95], v[30:31], v[16:17], 0
    v_exp_f32 v66, v66
    v_exp_f32 v67, v67
    v_exp_f32 v68, v68
    v_exp_f32 v69, v69
    v_mfma_f32_32x32x16_bf16 v[80:95], v[24:27], v[8:11], v[80:95]
    v_exp_f32 v70, v70
    v_exp_f32 v71, v71
    v_exp_f32 v72, v72
    v_exp_f32 v73, v73
    v_smfmac_f32_32x32x32_bf16 v[112:127], v[40:43], v[56:63], v144
    s_waitcnt lgkmcnt(0)
    ds_read_b128 v[20:23], v146 offset:20992
    v_exp_f32 v74, v74
    v_exp_f32 v75, v75
    v_exp_f32 v76, v76
    v_exp_f32 v77, v77
    v_smfmac_f32_32x32x32_bf16 v[128:143], v[32:35], v[64:71], v144
    ds_read_b32 v28, v147 offset:22016
    v_exp_f32 v78, v78
    v_exp_f32 v79, v79
    v_exp_f32 v80, v80
    v_exp_f32 v81, v81
    v_mfma_f32_32x32x8_bf16 v[96:111], v[30:31], v[18:19], 0
    v_exp_f32 v82, v82
    v_exp_f32 v83, v83
    v_exp_f32 v84, v84
    v_exp_f32 v85, v85
    v_mfma_f32_32x32x16_bf16 v[96:111], v[24:27], v[12:15], v[96:111]
    v_exp_f32 v86, v86
    v_exp_f32 v87, v87
    v_exp_f32 v88, v88
    v_exp_f32 v89, v89
    v_smfmac_f32_32x32x32_bf16 v[128:143], v[40:43], v[72:79], v144
    s_waitcnt lgkmcnt(0)
    ds_read_b128 v[40:43], v148 offset:22944
    v_exp_f32 v90, v90
    v_exp_f32 v91, v91
    v_exp_f32 v92, v92
    v_exp_f32 v93, v93
    v_smfmac_f32_32x32x32_bf16 v[112:127], v[36:39], v[80:87], v144
    ds_read_b128 v[32:35], v148 offset:22272
    v_exp_f32 v94, v94
    v_exp_f32 v95, v95
    v_exp_f32 v96, v96
    v_exp_f32 v97, v97
    v_mfma_f32_32x32x8_bf16 v[48:63], v[28:29], v[16:17], 0
    v_exp_f32 v98, v98
    v_exp_f32 v99, v99
    v_exp_f32 v100, v100
    v_exp_f32 v101, v101
    v_mfma_f32_32x32x16_bf16 v[48:63], v[20:23], v[8:11], v[48:63]
    s_cmp_eq_u32 s88, 0
    v_exp_f32 v102, v102
    v_exp_f32 v103, v103
    v_exp_f32 v104, v104
    v_exp_f32 v105, v105
    v_smfmac_f32_32x32x32_bf16 v[112:127], v[44:47], v[88:95], v144
    s_waitcnt lgkmcnt(0)
    ds_read_b128 v[24:27], v146 offset:26240
    v_exp_f32 v106, v106
    v_exp_f32 v107, v107
    v_exp_f32 v108, v108
    v_exp_f32 v109, v109
    v_smfmac_f32_32x32x32_bf16 v[128:143], v[36:39], v[96:103], v144
    ds_read_b32 v30, v147 offset:27264
    v_exp_f32 v110, v110
    v_exp_f32 v111, v111
    s_cbranch_scc1 L_bar0
L_bar0_ret:
    v_exp_f32 v48, v48
    v_exp_f32 v49, v49
    v_mfma_f32_32x32x8_bf16 v[64:79], v[28:29], v[18:19], 0
    v_exp_f32 v50, v50
    v_exp_f32 v51, v51
    v_exp_f32 v52, v52
    v_exp_f32 v53, v53
    v_mfma_f32_32x32x16_bf16 v[64:79], v[20:23], v[12:15], v[64:79]
    v_exp_f32 v54, v54
    v_exp_f32 v55, v55
    v_exp_f32 v56, v56
    v_exp_f32 v57, v57
    v_smfmac_f32_32x32x32_bf16 v[128:143], v[44:47], v[104:111], v144
    s_waitcnt lgkmcnt(0)
    ds_read_b128 v[44:47], v148 offset:28192
    v_exp_f32 v58, v58
    v_exp_f32 v59, v59
    v_exp_f32 v60, v60
    v_exp_f32 v61, v61
    v_smfmac_f32_32x32x32_bf16 v[112:127], v[32:35], v[48:55], v144
    ds_read_b128 v[36:39], v148 offset:27520
    v_exp_f32 v62, v62
    v_exp_f32 v63, v63
    v_exp_f32 v64, v64
    v_exp_f32 v65, v65
    v_mfma_f32_32x32x8_bf16 v[80:95], v[30:31], v[16:17], 0
    v_exp_f32 v66, v66
    v_exp_f32 v67, v67
    v_exp_f32 v68, v68
    v_exp_f32 v69, v69
    v_mfma_f32_32x32x16_bf16 v[80:95], v[24:27], v[8:11], v[80:95]
    v_exp_f32 v70, v70
    v_exp_f32 v71, v71
    v_exp_f32 v72, v72
    v_exp_f32 v73, v73
    v_smfmac_f32_32x32x32_bf16 v[112:127], v[40:43], v[56:63], v144
    s_waitcnt lgkmcnt(0)
    ds_read_b128 v[20:23], v146 offset:31488
    v_exp_f32 v74, v74
    v_exp_f32 v75, v75
    v_exp_f32 v76, v76
    v_exp_f32 v77, v77
    v_smfmac_f32_32x32x32_bf16 v[128:143], v[32:35], v[64:71], v144
    ds_read_b32 v28, v147 offset:32512
    v_exp_f32 v78, v78
    v_exp_f32 v79, v79
    v_exp_f32 v80, v80
    v_exp_f32 v81, v81
    v_mfma_f32_32x32x8_bf16 v[96:111], v[30:31], v[18:19], 0
    v_exp_f32 v82, v82
    v_exp_f32 v83, v83
    v_exp_f32 v84, v84
    v_exp_f32 v85, v85
    v_mfma_f32_32x32x16_bf16 v[96:111], v[24:27], v[12:15], v[96:111]
    v_exp_f32 v86, v86
    v_exp_f32 v87, v87
    v_exp_f32 v88, v88
    v_exp_f32 v89, v89
    v_smfmac_f32_32x32x32_bf16 v[128:143], v[40:43], v[72:79], v144
    s_waitcnt lgkmcnt(0)
    ds_read_b128 v[40:43], v148 offset:33440
    v_exp_f32 v90, v90
    v_exp_f32 v91, v91
    v_exp_f32 v92, v92
    v_exp_f32 v93, v93
    v_smfmac_f32_32x32x32_bf16 v[112:127], v[36:39], v[80:87], v144
    ds_read_b128 v[32:35], v148 offset:32768
    v_exp_f32 v94, v94
    v_exp_f32 v95, v95
    v_exp_f32 v96, v96
    v_exp_f32 v97, v97
    v_mfma_f32_32x32x8_bf16 v[48:63], v[28:29], v[16:17], 0
    v_exp_f32 v98, v98
    v_exp_f32 v99, v99
    v_exp_f32 v100, v100
    v_exp_f32 v101, v101
    v_mfma_f32_32x32x16_bf16 v[48:63], v[20:23], v[8:11], v[48:63]
    v_exp_f32 v102, v102
    v_exp_f32 v103, v103
    v_exp_f32 v104, v104
    v_exp_f32 v105, v105
    v_smfmac_f32_32x32x32_bf16 v[112:127], v[44:47], v[88:95], v144
    s_waitcnt lgkmcnt(0)
    ds_read_b128 v[24:27], v157 offset:0
    v_exp_f32 v106, v106
    v_exp_f32 v107, v107
    v_exp_f32 v108, v108
    v_exp_f32 v109, v109
    v_smfmac_f32_32x32x32_bf16 v[128:143], v[36:39], v[96:103], v144
    ds_read_b32 v30, v158 offset:1024
    v_exp_f32 v110, v110
    v_exp_f32 v111, v111
    v_exp_f32 v48, v48
    v_exp_f32 v49, v49
    v_mfma_f32_32x32x8_bf16 v[64:79], v[28:29], v[18:19], 0
    v_exp_f32 v50, v50
    v_exp_f32 v51, v51
    v_exp_f32 v52, v52
    v_exp_f32 v53, v53
    v_mfma_f32_32x32x16_bf16 v[64:79], v[20:23], v[12:15], v[64:79]
    v_exp_f32 v54, v54
    v_exp_f32 v55, v55
    v_exp_f32 v56, v56
    v_exp_f32 v57, v57
    v_smfmac_f32_32x32x32_bf16 v[128:143], v[44:47], v[104:111], v144
    s_waitcnt lgkmcnt(0)
    ds_read_b128 v[44:47], v159 offset:1952
    v_exp_f32 v58, v58
    v_exp_f32 v59, v59
    v_exp_f32 v60, v60
    v_exp_f32 v61, v61
    v_smfmac_f32_32x32x32_bf16 v[112:127], v[32:35], v[48:55], v144
    ds_read_b128 v[36:39], v159 offset:1280
    v_exp_f32 v62, v62
    v_exp_f32 v63, v63
    v_exp_f32 v64, v64
    v_exp_f32 v65, v65
    v_mfma_f32_32x32x8_bf16 v[80:95], v[30:31], v[16:17], 0
    v_exp_f32 v66, v66
    v_exp_f32 v67, v67
    v_exp_f32 v68, v68
    v_exp_f32 v69, v69
    v_mfma_f32_32x32x16_bf16 v[80:95], v[24:27], v[8:11], v[80:95]
    v_exp_f32 v70, v70
    v_exp_f32 v71, v71
    v_exp_f32 v72, v72
    v_exp_f32 v73, v73
    v_smfmac_f32_32x32x32_bf16 v[112:127], v[40:43], v[56:63], v144
    s_waitcnt lgkmcnt(0)
    ds_read_b128 v[20:23], v146 offset:41984
    v_exp_f32 v74, v74
    v_exp_f32 v75, v75
    v_exp_f32 v76, v76
    v_exp_f32 v77, v77
    v_smfmac_f32_32x32x32_bf16 v[128:143], v[32:35], v[64:71], v144
    ds_read_b32 v28, v147 offset:43008
    v_exp_f32 v78, v78
    v_exp_f32 v79, v79
    v_exp_f32 v80, v80
    v_exp_f32 v81, v81
    v_mfma_f32_32x32x8_bf16 v[96:111], v[30:31], v[18:19], 0
    v_exp_f32 v82, v82
    v_exp_f32 v83, v83
    v_exp_f32 v84, v84
    v_exp_f32 v85, v85
    v_mfma_f32_32x32x16_bf16 v[96:111], v[24:27], v[12:15], v[96:111]
    s_cmp_eq_u32 s88, 2
    s_cselect_b32 s89, 4294846592, s39
    v_exp_f32 v86, v86
    v_exp_f32 v87, v87
    v_exp_f32 v88, v88
    v_exp_f32 v89, v89
    v_smfmac_f32_32x32x32_bf16 v[128:143], v[40:43], v[72:79], v144
    s_waitcnt lgkmcnt(0)
    ds_read_b128 v[40:43], v148 offset:43936
    v_exp_f32 v90, v90
    v_exp_f32 v91, v91
    v_exp_f32 v92, v92
    v_exp_f32 v93, v93
    v_smfmac_f32_32x32x32_bf16 v[112:127], v[36:39], v[80:87], v144
    ds_read_b128 v[32:35], v148 offset:43264
    v_exp_f32 v94, v94
    v_exp_f32 v95, v95
    v_exp_f32 v96, v96
    v_exp_f32 v97, v97
    v_mfma_f32_32x32x8_bf16 v[48:63], v[28:29], v[16:17], 0
    v_exp_f32 v98, v98
    v_exp_f32 v99, v99
    v_exp_f32 v100, v100
    v_exp_f32 v101, v101
    v_mfma_f32_32x32x16_bf16 v[48:63], v[20:23], v[8:11], v[48:63]
    s_add_u32 s88, s88, 1
    s_cmp_eq_u32 s88, 1
    v_exp_f32 v102, v102
    v_exp_f32 v103, v103
    v_exp_f32 v104, v104
    v_exp_f32 v105, v105
    v_smfmac_f32_32x32x32_bf16 v[112:127], v[44:47], v[88:95], v144
    s_waitcnt lgkmcnt(0)
    ds_read_b128 v[24:27], v146 offset:47232
    v_exp_f32 v106, v106
    v_exp_f32 v107, v107
    v_exp_f32 v108, v108
    v_exp_f32 v109, v109
    v_smfmac_f32_32x32x32_bf16 v[128:143], v[36:39], v[96:103], v144
    ds_read_b32 v30, v147 offset:48256
    v_exp_f32 v110, v110
    v_exp_f32 v111, v111
    v_add_u32 v146, 41984, v146
    v_add_u32 v147, 41984, v147
    v_add_u32 v148, 41984, v148
    v_add_u32 v157, s89, v157
    v_add_u32 v158, s89, v158
    v_add_u32 v159, s89, v159
    s_cbranch_scc1 L_loop
    s_cmp_eq_u32 s88, 4
    s_cbranch_scc1 L_fin
    s_waitcnt lgkmcnt(0)
    s_cmp_eq_u32 s88, 3
    s_cbranch_scc1 L_prog
    s_barrier
    s_branch L_loop

L_prog:
    v_mov_b32 v6, 162816
    v_mov_b32 v2, 1
    s_mov_b64 exec, 1
    ds_add_u32 v6, v2 offset:8
    s_mov_b64 exec, -1
    ds_read_b32 v5, v6 offset:4
    s_lshl_b32 s38, s32, 2
    s_add_u32 s38, s38, 163600
    v_mov_b32 v1, s38
    v_xor_b32 v7, 4, v1
    s_branch L_loop

L_bar0:
    s_waitcnt lgkmcnt(0)
    s_barrier
    s_branch L_bar0_ret
L_fin:
    v_smfmac_f32_32x32x32_bf16 v[128:143], v[44:47], v[104:111], v144
    v_cmp_eq_u32 vcc, 0, v5
    s_mov_b32 s88, 0
    s_cbranch_vccz L_rdy

L_rdy_spin:
    s_sleep 1
    ds_read_b32 v5, v6 offset:4
    s_add_u32 s88, s88, 1
    s_cmp_gt_u32 s88, 160000
    s_cbranch_scc1 L_rdy
    s_waitcnt lgkmcnt(0)
    v_cmp_eq_u32 vcc, 0, v5
    s_cbranch_vccnz L_rdy_spin

L_rdy:
    ds_write_b128 v161, v[112:115]
    ds_write_b128 v161, v[116:119] offset:1024
    ds_write_b128 v161, v[120:123] offset:2048
    ds_write_b32 v1, v2
    s_mov_b32 s38, 0x5f800000
    s_mov_b32 s39, 0x1f800000

L_pair_spin:
    ds_read_b32 v3, v7
    ds_read_b128 v[56:59], v162 offset:2048
    ds_read_b128 v[48:51], v162
    ds_read_b128 v[52:55], v162 offset:1024
    s_add_u32 s88, s88, 1
    s_cmp_gt_u32 s88, 160000
    s_cbranch_scc1 L_pair
    s_waitcnt lgkmcnt(3)
    v_cmp_eq_u32 vcc, 0, v3
    s_cbranch_vccz L_pair
    s_sleep 1
    s_branch L_pair_spin

L_pair:
    s_waitcnt lgkmcnt(2)
    v_add_f32 v136, v136, v56
    v_add_f32 v137, v137, v57
    v_add_f32 v138, v138, v58
    v_add_f32 v139, v139, v59
    v_mov_b32 v3, v136
    v_mov_b32 v4, v136
    s_nop 1
    v_permlane32_swap_b32 v3, v4

    s_waitcnt lgkmcnt(0)
    v_add_f32 v128, v128, v48
    v_add_f32 v129, v129, v49
    v_add_f32 v130, v130, v50
    v_add_f32 v131, v131, v51
    v_add_f32 v132, v132, v52
    v_add_f32 v133, v133, v53
    v_add_f32 v134, v134, v54
    v_add_f32 v135, v135, v55
    v_maximum3_f32 v1, abs(v128), abs(v129), abs(v130)
    v_maximum3_f32 v2, abs(v131), abs(v132), abs(v133)
    v_maximum3_f32 v1, v1, abs(v134), abs(v135)
    v_maximum3_f32 v2, v2, abs(v136), abs(v137)
    v_maximum3_f32 v1, v1, abs(v138), abs(v139)
    v_add_f32 v1, v1, v2
    v_fma_f32 v1, 0, v1, v4
    v_cmp_nge_f32 vcc, s38, v1
    v_cmp_gt_f32 s[6:7], s39, v1
    s_or_b64 vcc, vcc, s[6:7]
    s_cbranch_vccnz L_fallback

L_store:
    v_rcp_f32 v1, v4
    s_mov_b32 s38, 0xfffffffe
    v_mul_f32 v128, v128, v1
    v_mul_f32 v129, v129, v1
    v_mul_f32 v130, v130, v1
    v_mul_f32 v131, v131, v1
    v_mul_f32 v132, v132, v1
    v_mul_f32 v133, v133, v1
    v_mul_f32 v134, v134, v1
    v_mul_f32 v135, v135, v1
    v_mul_f32 v136, v136, v1
    v_mul_f32 v137, v137, v1
    v_mul_f32 v138, v138, v1
    v_mul_f32 v139, v139, v1
    v_cvt_pk_bf16_f32 v48, v128, v129
    v_cvt_pk_bf16_f32 v49, v130, v131
    v_cvt_pk_bf16_f32 v50, v132, v133
    v_cvt_pk_bf16_f32 v51, v134, v135
    v_cvt_pk_bf16_f32 v52, v136, v137
    v_cvt_pk_bf16_f32 v53, v138, v139
    v_min_u32 v48, s38, v48
    v_min_u32 v49, s38, v49
    v_min_u32 v50, s38, v50
    v_min_u32 v51, s38, v51
    v_min_u32 v52, s38, v52
    v_min_u32 v53, s38, v53
    v_cmp_eq_u32 vcc, 3, v5
    s_cbranch_vccnz L_st_fast
    buffer_store_dwordx4 v[48:51], v163, s[8:11], s83 offen sc1
    s_mov_b64 exec, s[4:5]
    buffer_store_dwordx2 v[52:53], v164, s[8:11], s84 offen sc1
    s_branch L_st_done

L_st_fast:
    buffer_store_dwordx4 v[48:51], v163, s[8:11], s83 offen
    s_mov_b64 exec, s[4:5]
    buffer_store_dwordx2 v[52:53], v164, s[8:11], s84 offen

L_st_done:
    s_mov_b64 exec, -1

    s_add_u32 s83, s85, 4096
    s_add_u32 s84, s85, 8192
    s_cmp_eq_u32 s82, 0
    s_cbranch_scc1 L_ph_ld
    v_mov_b32 v2, 1
    s_mov_b64 exec, 1
    ds_add_u32 v6, v2 offset:816
    s_mov_b64 exec, -1

    s_mov_b32 s39, 0
L_lwy:
    ds_read_b32 v2, v6 offset:816
    s_add_u32 s39, s39, 1
    s_cmp_gt_u32 s39, 160000
    s_waitcnt lgkmcnt(0)
    s_cbranch_scc1 L_lwy_done
    v_readfirstlane_b32 s38, v2
    s_nop 0
    s_cmp_eq_u32 s38, 4
    s_cbranch_scc1 L_lwy_done

    s_branch L_lwy

L_lwy_done:
L_ph_ld:
    s_cmp_lg_u32 s82, 0
    s_cbranch_scc1 L_ph_ld2
    s_setprio 0

L_ph_ld2:
    buffer_load_dwordx4 v[8:11], v150, s[8:11], s85 offen offset:0 sc1
    buffer_load_dwordx4 v[12:15], v150, s[8:11], s85 offen offset:1024 sc1
    buffer_load_dwordx4 v[16:19], v150, s[8:11], s85 offen offset:2048 sc1
    buffer_load_dwordx4 v[20:23], v150, s[8:11], s85 offen offset:3072 sc1
    buffer_load_dwordx4 v[24:27], v150, s[8:11], s83 offen offset:0 sc1
    buffer_load_dwordx4 v[28:31], v150, s[8:11], s83 offen offset:1024 sc1
    buffer_load_dwordx4 v[32:35], v150, s[8:11], s83 offen offset:2048 sc1
    buffer_load_dwordx4 v[36:39], v150, s[8:11], s83 offen offset:3072 sc1
    buffer_load_dwordx4 v[40:43], v150, s[8:11], s84 offen offset:0 sc1
    buffer_load_dwordx4 v[44:47], v150, s[8:11], s84 offen offset:1024 sc1
    s_and_b32 s38, s32, 3
    s_lshl_b32 s38, s38, 4
    v_add_u32 v1, s38, v155
    v_lshlrev_b32 v2, 2, v1
    v_add_u32 v2, 163344, v2
    ds_read_b32 v158, v2
    ds_read_b32 v7, v6
    s_mul_i32 s38, s38, 320
    s_add_u32 s38, s38, 132224
    v_add_u32 v161, s38, v150
    s_mul_i32 s38, s82, 51200
    s_add_u32 s38, s38, 29824
    v_lshrrev_b32 v2, 2, v155
    v_and_b32 v3, 3, v145
    v_mad_u32_u24 v4, v154, 12, v2
    v_lshl_add_u32 v4, v156, 2, v4
    v_mad_u32_u24 v5, v156, 40, v2
    v_mul_u32_u24 v4, 160, v4
    v_mul_u32_u24 v5, 160, v5
    v_add_u32 v4, s38, v4
    v_add_u32 v5, s38, v5
    v_lshl_add_u32 v146, v3, 4, v4
    v_lshl_add_u32 v147, v3, 3, v4
    v_lshl_add_u32 v148, v3, 4, v5
    v_lshl_add_u32 v152, v3, 3, v5
    v_mul_u32_u24 v2, 1280, v155
    v_lshl_add_u32 v157, v156, 4, v2
    v_lshl_add_u32 v162, v156, 3, v2
    s_and_b32 s38, s32, 3
    s_lshl_b32 s38, s38, 2
    v_add_u32 v163, s38, v6
    s_mov_b32 s88, 0
    s_waitcnt lgkmcnt(0)
    v_cmp_eq_u32 s[6:7], v7, v1
    s_cmp_eq_u32 s82, 0
    s_cbranch_scc1 L_ph

    s_mov_b32 s39, 0
L_lww:
    ds_read_b32 v2, v6 offset:12
    s_add_u32 s39, s39, 1
    s_cmp_gt_u32 s39, 160000
    s_waitcnt lgkmcnt(0)
    s_cbranch_scc1 L_lww_done
    v_readfirstlane_b32 s38, v2
    s_nop 0
    s_cmp_eq_u32 s38, 1
    s_cbranch_scc1 L_lww_done
    s_sleep 1
    s_branch L_lww

L_lww_done:
L_ph:
    ds_read_b64_tr_b16 v[48:49], v146 offset:0
    ds_read_b64_tr_b16 v[50:51], v146 offset:1280
    ds_read_b64_tr_b16 v[52:53], v146 offset:8
    ds_read_b64_tr_b16 v[54:55], v146 offset:1288
    ds_read_b64_tr_b16 v[56:57], v146 offset:64
    ds_read_b64_tr_b16 v[58:59], v146 offset:1344
    ds_read_b64_tr_b16 v[60:61], v146 offset:72
    ds_read_b64_tr_b16 v[62:63], v146 offset:1352
    ds_read_b64_tr_b16 v[64:65], v147 offset:128
    ds_read_b64_tr_b16 v[66:67], v147 offset:1408
    ds_read_b64_tr_b16 v[68:69], v146 offset:6400
    ds_read_b64_tr_b16 v[70:71], v146 offset:7680
    ds_read_b64_tr_b16 v[72:73], v146 offset:6408
    ds_read_b64_tr_b16 v[74:75], v146 offset:7688
    ds_read_b64_tr_b16 v[76:77], v146 offset:6464
    ds_read_b64_tr_b16 v[78:79], v146 offset:7744
    ds_read_b64_tr_b16 v[80:81], v146 offset:6472
    ds_read_b64_tr_b16 v[82:83], v146 offset:7752
    ds_read_b64_tr_b16 v[84:85], v147 offset:6528
    ds_read_b64_tr_b16 v[86:87], v147 offset:7808
    ds_read_b64_tr_b16 v[88:89], v146 offset:12800
    ds_read_b64_tr_b16 v[90:91], v146 offset:14080
    ds_read_b64_tr_b16 v[92:93], v146 offset:12808
    ds_read_b64_tr_b16 v[94:95], v146 offset:14088
    ds_read_b64_tr_b16 v[96:97], v146 offset:12864
    ds_read_b64_tr_b16 v[98:99], v146 offset:14144
    ds_read_b64_tr_b16 v[100:101], v146 offset:12872
    ds_read_b64_tr_b16 v[102:103], v146 offset:14152
    ds_read_b64_tr_b16 v[104:105], v147 offset:12928
    ds_read_b64_tr_b16 v[106:107], v147 offset:14208
    s_waitcnt vmcnt(5)
L_chk0:
    v_max3_u32 v4, v8, v9, v10
    v_max3_u32 v5, v11, v12, v13
    v_max3_u32 v5, v5, v14, v15
    v_max3_u32 v4, v4, v16, v17
    v_max3_u32 v5, v5, v18, v19
    v_max3_u32 v4, v4, v20, v21
    v_max3_u32 v5, v5, v22, v23
    v_max3_u32 v4, v4, v24, v25
    v_max3_u32 v5, v5, v26, v27
    v_max_u32 v4, v4, v5
    v_cmp_eq_u32 vcc, -1, v4
    s_cbranch_vccz L_ok0
    s_add_u32 s88, s88, 1
    s_cmp_gt_u32 s88, 20000
    s_cbranch_scc1 L_ok0
    s_cmp_lg_u32 s82, 0
    s_cbranch_scc1 L_nosl0
    s_sleep 4

L_nosl0:
    buffer_load_dwordx4 v[8:11], v150, s[8:11], s85 offen offset:0 sc1
    buffer_load_dwordx4 v[12:15], v150, s[8:11], s85 offen offset:1024 sc1
    buffer_load_dwordx4 v[16:19], v150, s[8:11], s85 offen offset:2048 sc1
    buffer_load_dwordx4 v[20:23], v150, s[8:11], s85 offen offset:3072 sc1
    buffer_load_dwordx4 v[24:27], v150, s[8:11], s83 offen offset:0 sc1
    buffer_load_dwordx4 v[28:31], v150, s[8:11], s83 offen offset:1024 sc1
    buffer_load_dwordx4 v[32:35], v150, s[8:11], s83 offen offset:2048 sc1
    buffer_load_dwordx4 v[36:39], v150, s[8:11], s83 offen offset:3072 sc1
    buffer_load_dwordx4 v[40:43], v150, s[8:11], s84 offen offset:0 sc1
    buffer_load_dwordx4 v[44:47], v150, s[8:11], s84 offen offset:1024 sc1
    s_waitcnt vmcnt(5)
    s_branch L_chk0
L_ok0:
    s_waitcnt lgkmcnt(10)
    v_mfma_f32_16x16x32_bf16 v[108:111], v[48:51], v[8:11], 0
    ds_read_b64_tr_b16 v[48:49], v146 offset:19200
    ds_read_b64_tr_b16 v[50:51], v146 offset:20480
    v_mfma_f32_16x16x32_bf16 v[112:115], v[52:55], v[8:11], 0
    ds_read_b64_tr_b16 v[52:53], v146 offset:19208
    ds_read_b64_tr_b16 v[54:55], v146 offset:20488
    v_mfma_f32_16x16x32_bf16 v[116:119], v[56:59], v[8:11], 0
    ds_read_b64_tr_b16 v[56:57], v146 offset:19264
    ds_read_b64_tr_b16 v[58:59], v146 offset:20544
    v_mfma_f32_16x16x32_bf16 v[120:123], v[60:63], v[8:11], 0
    ds_read_b64_tr_b16 v[60:61], v146 offset:19272
    ds_read_b64_tr_b16 v[62:63], v146 offset:20552
    v_mfma_f32_16x16x32_bf16 v[124:127], v[64:67], v[8:11], 0
    ds_read_b64_tr_b16 v[64:65], v147 offset:19328
    ds_read_b64_tr_b16 v[66:67], v147 offset:20608
    s_waitcnt lgkmcnt(10)
    v_mfma_f32_16x16x32_bf16 v[108:111], v[68:71], v[12:15], v[108:111]
    ds_read_b64_tr_b16 v[68:69], v148 offset:2560
    ds_read_b64_tr_b16 v[70:71], v148 offset:5760
    v_mfma_f32_16x16x32_bf16 v[112:115], v[72:75], v[12:15], v[112:115]
    ds_read_b64_tr_b16 v[72:73], v148 offset:2568
    ds_read_b64_tr_b16 v[74:75], v148 offset:5768
    v_mfma_f32_16x16x32_bf16 v[116:119], v[76:79], v[12:15], v[116:119]
    ds_read_b64_tr_b16 v[76:77], v148 offset:2624
    ds_read_b64_tr_b16 v[78:79], v148 offset:5824
    v_mfma_f32_16x16x32_bf16 v[120:123], v[80:83], v[12:15], v[120:123]
    ds_read_b64_tr_b16 v[80:81], v148 offset:2632
    ds_read_b64_tr_b16 v[82:83], v148 offset:5832
    v_mfma_f32_16x16x32_bf16 v[124:127], v[84:87], v[12:15], v[124:127]
    ds_read_b64_tr_b16 v[84:85], v152 offset:2688
    ds_read_b64_tr_b16 v[86:87], v152 offset:5888
    s_waitcnt lgkmcnt(10)
    v_mfma_f32_16x16x32_bf16 v[108:111], v[88:91], v[16:19], v[108:111]
    ds_read_b64_tr_b16 v[88:89], v146 offset:25600
    ds_read_b64_tr_b16 v[90:91], v146 offset:26880
    v_mfma_f32_16x16x32_bf16 v[112:115], v[92:95], v[16:19], v[112:115]
    ds_read_b64_tr_b16 v[92:93], v146 offset:25608
    ds_read_b64_tr_b16 v[94:95], v146 offset:26888
    v_mfma_f32_16x16x32_bf16 v[116:119], v[96:99], v[16:19], v[116:119]
    ds_read_b64_tr_b16 v[96:97], v146 offset:25664
    ds_read_b64_tr_b16 v[98:99], v146 offset:26944
    v_mfma_f32_16x16x32_bf16 v[120:123], v[100:103], v[16:19], v[120:123]
    ds_read_b64_tr_b16 v[100:101], v146 offset:25672
    ds_read_b64_tr_b16 v[102:103], v146 offset:26952
    v_mfma_f32_16x16x32_bf16 v[124:127], v[104:107], v[16:19], v[124:127]
    ds_read_b64_tr_b16 v[104:105], v147 offset:25728
    ds_read_b64_tr_b16 v[106:107], v147 offset:27008
    s_waitcnt lgkmcnt(10)
    v_mfma_f32_16x16x32_bf16 v[108:111], v[48:51], v[20:23], v[108:111]
    ds_read_b64_tr_b16 v[48:49], v146 offset:32000
    ds_read_b64_tr_b16 v[50:51], v146 offset:33280
    v_mfma_f32_16x16x32_bf16 v[112:115], v[52:55], v[20:23], v[112:115]
    ds_read_b64_tr_b16 v[52:53], v146 offset:32008
    ds_read_b64_tr_b16 v[54:55], v146 offset:33288
    v_mfma_f32_16x16x32_bf16 v[116:119], v[56:59], v[20:23], v[116:119]
    ds_read_b64_tr_b16 v[56:57], v146 offset:32064
    ds_read_b64_tr_b16 v[58:59], v146 offset:33344
    v_mfma_f32_16x16x32_bf16 v[120:123], v[60:63], v[20:23], v[120:123]
    ds_read_b64_tr_b16 v[60:61], v146 offset:32072
    ds_read_b64_tr_b16 v[62:63], v146 offset:33352
    v_mfma_f32_16x16x32_bf16 v[124:127], v[64:67], v[20:23], v[124:127]
    ds_read_b64_tr_b16 v[64:65], v147 offset:32128
    ds_read_b64_tr_b16 v[66:67], v147 offset:33408
    s_waitcnt lgkmcnt(10)
    v_mfma_f32_16x16x32_bf16 v[108:111], v[68:71], v[24:27], v[108:111]
    ds_read_b64_tr_b16 v[68:69], v146 offset:38400
    ds_read_b64_tr_b16 v[70:71], v146 offset:39680
    v_mfma_f32_16x16x32_bf16 v[112:115], v[72:75], v[24:27], v[112:115]
    ds_read_b64_tr_b16 v[72:73], v146 offset:38408
    ds_read_b64_tr_b16 v[74:75], v146 offset:39688
    v_mfma_f32_16x16x32_bf16 v[116:119], v[76:79], v[24:27], v[116:119]
    ds_read_b64_tr_b16 v[76:77], v146 offset:38464
    ds_read_b64_tr_b16 v[78:79], v146 offset:39744
    v_mfma_f32_16x16x32_bf16 v[120:123], v[80:83], v[24:27], v[120:123]
    ds_read_b64_tr_b16 v[80:81], v146 offset:38472
    ds_read_b64_tr_b16 v[82:83], v146 offset:39752
    v_mfma_f32_16x16x32_bf16 v[124:127], v[84:87], v[24:27], v[124:127]
    ds_read_b64_tr_b16 v[84:85], v147 offset:38528
    ds_read_b64_tr_b16 v[86:87], v147 offset:39808
    s_waitcnt vmcnt(0)
L_chk1:
    v_max3_u32 v4, v28, v29, v30
    v_max3_u32 v5, v31, v32, v33
    v_max3_u32 v5, v5, v34, v35
    v_max3_u32 v4, v4, v36, v37
    v_max3_u32 v5, v5, v38, v39
    v_max3_u32 v4, v4, v40, v41
    v_max3_u32 v5, v5, v42, v43
    v_max3_u32 v4, v4, v44, v45
    v_max3_u32 v5, v5, v46, v47
    v_max_u32 v4, v4, v5
    v_cmp_eq_u32 vcc, -1, v4
    s_cbranch_vccz L_ok1
    s_add_u32 s88, s88, 1
    s_cmp_gt_u32 s88, 20000
    s_cbranch_scc1 L_ok1
    s_cmp_lg_u32 s82, 0
    s_cbranch_scc1 L_nosl1
    s_sleep 4

L_nosl1:
    buffer_load_dwordx4 v[28:31], v150, s[8:11], s83 offen offset:1024 sc1
    buffer_load_dwordx4 v[32:35], v150, s[8:11], s83 offen offset:2048 sc1
    buffer_load_dwordx4 v[36:39], v150, s[8:11], s83 offen offset:3072 sc1
    buffer_load_dwordx4 v[40:43], v150, s[8:11], s84 offen offset:0 sc1
    buffer_load_dwordx4 v[44:47], v150, s[8:11], s84 offen offset:1024 sc1
    s_waitcnt vmcnt(0)
    s_branch L_chk1
L_ok1:
    s_cmp_lg_u32 s82, 0
    s_cbranch_scc1 L_nox
    buffer_load_dwordx4 v[128:131], v157, s[16:19], s86 offen
    buffer_load_dwordx4 v[132:135], v157, s[16:19], s86 offen offset:64
    buffer_load_dwordx2 v[136:137], v162, s[16:19], s86 offen offset:128
L_nox:
    s_waitcnt lgkmcnt(10)
    v_mfma_f32_16x16x32_bf16 v[108:111], v[88:91], v[28:31], v[108:111]
    ds_read_b64_tr_b16 v[88:89], v146 offset:44800
    ds_read_b64_tr_b16 v[90:91], v146 offset:46080
    v_mfma_f32_16x16x32_bf16 v[112:115], v[92:95], v[28:31], v[112:115]
    ds_read_b64_tr_b16 v[92:93], v146 offset:44808
    ds_read_b64_tr_b16 v[94:95], v146 offset:46088
    v_mfma_f32_16x16x32_bf16 v[116:119], v[96:99], v[28:31], v[116:119]
    ds_read_b64_tr_b16 v[96:97], v146 offset:44864
    ds_read_b64_tr_b16 v[98:99], v146 offset:46144
    v_mfma_f32_16x16x32_bf16 v[120:123], v[100:103], v[28:31], v[120:123]
    ds_read_b64_tr_b16 v[100:101], v146 offset:44872
    ds_read_b64_tr_b16 v[102:103], v146 offset:46152
    v_mfma_f32_16x16x32_bf16 v[124:127], v[104:107], v[28:31], v[124:127]
    ds_read_b64_tr_b16 v[104:105], v147 offset:44928
    ds_read_b64_tr_b16 v[106:107], v147 offset:46208
    s_waitcnt lgkmcnt(10)
    v_mfma_f32_16x16x32_bf16 v[108:111], v[48:51], v[32:35], v[108:111]
    ds_read_b64_tr_b16 v[48:49], v148 offset:28160
    ds_read_b64_tr_b16 v[50:51], v148 offset:31360
    v_mfma_f32_16x16x32_bf16 v[112:115], v[52:55], v[32:35], v[112:115]
    ds_read_b64_tr_b16 v[52:53], v148 offset:28168
    ds_read_b64_tr_b16 v[54:55], v148 offset:31368
    v_mfma_f32_16x16x32_bf16 v[116:119], v[56:59], v[32:35], v[116:119]
    ds_read_b64_tr_b16 v[56:57], v148 offset:28224
    ds_read_b64_tr_b16 v[58:59], v148 offset:31424
    v_mfma_f32_16x16x32_bf16 v[120:123], v[60:63], v[32:35], v[120:123]
    ds_read_b64_tr_b16 v[60:61], v148 offset:28232
    ds_read_b64_tr_b16 v[62:63], v148 offset:31432
    v_mfma_f32_16x16x32_bf16 v[124:127], v[64:67], v[32:35], v[124:127]
    ds_read_b64_tr_b16 v[64:65], v152 offset:28288
    ds_read_b64_tr_b16 v[66:67], v152 offset:31488
    s_waitcnt lgkmcnt(10)
    v_mfma_f32_16x16x32_bf16 v[108:111], v[68:71], v[36:39], v[108:111]
    v_mfma_f32_16x16x32_bf16 v[112:115], v[72:75], v[36:39], v[112:115]
    v_mfma_f32_16x16x32_bf16 v[116:119], v[76:79], v[36:39], v[116:119]
    v_mfma_f32_16x16x32_bf16 v[120:123], v[80:83], v[36:39], v[120:123]
    v_mfma_f32_16x16x32_bf16 v[124:127], v[84:87], v[36:39], v[124:127]
    s_waitcnt lgkmcnt(0)
    v_mfma_f32_16x16x32_bf16 v[108:111], v[88:91], v[40:43], v[108:111]
    v_mfma_f32_16x16x32_bf16 v[112:115], v[92:95], v[40:43], v[112:115]
    v_mfma_f32_16x16x32_bf16 v[116:119], v[96:99], v[40:43], v[116:119]
    v_mfma_f32_16x16x32_bf16 v[120:123], v[100:103], v[40:43], v[120:123]
    v_mfma_f32_16x16x32_bf16 v[124:127], v[104:107], v[40:43], v[124:127]
    s_waitcnt lgkmcnt(0)
    v_mfma_f32_16x16x32_bf16 v[108:111], v[48:51], v[44:47], v[108:111]
    v_mfma_f32_16x16x32_bf16 v[112:115], v[52:55], v[44:47], v[112:115]
    v_mfma_f32_16x16x32_bf16 v[116:119], v[56:59], v[44:47], v[116:119]
    v_mfma_f32_16x16x32_bf16 v[120:123], v[60:63], v[44:47], v[120:123]
    v_mfma_f32_16x16x32_bf16 v[124:127], v[64:67], v[44:47], v[124:127]
    s_cmp_lg_u32 s82, 0
    s_cbranch_scc1 L_epi
    s_waitcnt vmcnt(0)
    s_cmp_eq_u64 s[6:7], 0
    s_cbranch_scc1 L_nosel

    s_mov_b32 s39, 0
L_lwu:
    ds_read_b32 v2, v6 offset:12
    s_add_u32 s39, s39, 1
    s_cmp_gt_u32 s39, 160000
    s_waitcnt lgkmcnt(0)
    s_cbranch_scc1 L_lwu_done
    v_readfirstlane_b32 s38, v2
    s_nop 0
    s_cmp_eq_u32 s38, 1
    s_cbranch_scc1 L_lwu_done
    s_sleep 2
    s_branch L_lwu

L_lwu_done:
    v_lshlrev_b32 v2, 5, v156
    v_add_u32 v2, 162832, v2
    v_lshlrev_b32 v3, 4, v156
    v_add_u32 v3, 163088, v3

    ds_read_b128 v[20:23], v2 offset:0
    ds_read_b128 v[24:27], v2 offset:16
    ds_read_b128 v[28:31], v2 offset:128
    ds_read_b128 v[32:35], v2 offset:144
    ds_read_b128 v[36:39], v3
    s_mov_b64 exec, s[6:7]
    s_waitcnt lgkmcnt(0)
    v_lshlrev_b32 v8, 16, v128
    v_and_b32 v9, 0xffff0000, v128
    v_add_f32 v8, v8, v20
    v_add_f32 v9, v9, v21
    v_cvt_pk_bf16_f32 v128, v8, v9
    v_lshlrev_b32 v8, 16, v129
    v_and_b32 v9, 0xffff0000, v129
    v_add_f32 v8, v8, v22
    v_add_f32 v9, v9, v23
    v_cvt_pk_bf16_f32 v129, v8, v9
    v_lshlrev_b32 v8, 16, v130
    v_and_b32 v9, 0xffff0000, v130
    v_add_f32 v8, v8, v24
    v_add_f32 v9, v9, v25
    v_cvt_pk_bf16_f32 v130, v8, v9
    v_lshlrev_b32 v8, 16, v131
    v_and_b32 v9, 0xffff0000, v131
    v_add_f32 v8, v8, v26
    v_add_f32 v9, v9, v27
    v_cvt_pk_bf16_f32 v131, v8, v9
    v_lshlrev_b32 v8, 16, v132
    v_and_b32 v9, 0xffff0000, v132
    v_add_f32 v8, v8, v28
    v_add_f32 v9, v9, v29
    v_cvt_pk_bf16_f32 v132, v8, v9
    v_lshlrev_b32 v8, 16, v133
    v_and_b32 v9, 0xffff0000, v133
    v_add_f32 v8, v8, v30
    v_add_f32 v9, v9, v31
    v_cvt_pk_bf16_f32 v133, v8, v9
    v_lshlrev_b32 v8, 16, v134
    v_and_b32 v9, 0xffff0000, v134
    v_add_f32 v8, v8, v32
    v_add_f32 v9, v9, v33
    v_cvt_pk_bf16_f32 v134, v8, v9
    v_lshlrev_b32 v8, 16, v135
    v_and_b32 v9, 0xffff0000, v135
    v_add_f32 v8, v8, v34
    v_add_f32 v9, v9, v35
    v_cvt_pk_bf16_f32 v135, v8, v9
    v_lshlrev_b32 v8, 16, v136
    v_and_b32 v9, 0xffff0000, v136
    v_add_f32 v8, v8, v36
    v_add_f32 v9, v9, v37
    v_cvt_pk_bf16_f32 v136, v8, v9
    v_lshlrev_b32 v8, 16, v137
    v_and_b32 v9, 0xffff0000, v137
    v_add_f32 v8, v8, v38
    v_add_f32 v9, v9, v39
    v_cvt_pk_bf16_f32 v137, v8, v9
    s_mov_b64 exec, -1
L_nosel:
    v_sub_f32 v159, 1.0, v158
    v_cvt_pk_bf16_f32 v159, v159, v159
    v_and_b32 v159, 0xffff0000, v159

    v_lshlrev_b32 v8, 16, v128
    v_and_b32 v9, 0xffff0000, v128
    v_lshlrev_b32 v10, 16, v129
    v_and_b32 v11, 0xffff0000, v129
    v_lshlrev_b32 v12, 16, v130
    v_and_b32 v13, 0xffff0000, v130
    v_lshlrev_b32 v14, 16, v131
    v_and_b32 v15, 0xffff0000, v131
    v_lshlrev_b32 v16, 16, v132
    v_and_b32 v17, 0xffff0000, v132
    v_lshlrev_b32 v18, 16, v133
    v_and_b32 v19, 0xffff0000, v133
    v_lshlrev_b32 v20, 16, v134
    v_and_b32 v21, 0xffff0000, v134
    v_lshlrev_b32 v22, 16, v135
    v_and_b32 v23, 0xffff0000, v135
    v_lshlrev_b32 v24, 16, v136
    v_and_b32 v25, 0xffff0000, v136
    v_lshlrev_b32 v26, 16, v137
    v_and_b32 v27, 0xffff0000, v137
    v_mul_f32 v8, v159, v8
    v_mul_f32 v9, v159, v9
    v_mul_f32 v10, v159, v10
    v_mul_f32 v11, v159, v11
    v_mul_f32 v12, v159, v12
    v_mul_f32 v13, v159, v13
    v_mul_f32 v14, v159, v14
    v_mul_f32 v15, v159, v15
    v_mul_f32 v16, v159, v16
    v_mul_f32 v17, v159, v17
    v_mul_f32 v18, v159, v18
    v_mul_f32 v19, v159, v19
    v_mul_f32 v20, v159, v20
    v_mul_f32 v21, v159, v21
    v_mul_f32 v22, v159, v22
    v_mul_f32 v23, v159, v23
    v_mul_f32 v24, v159, v24
    v_mul_f32 v25, v159, v25
    v_mul_f32 v26, v159, v26
    v_mul_f32 v27, v159, v27
    v_fma_f32 v108, v158, v108, v8
    v_fma_f32 v109, v158, v109, v9
    v_fma_f32 v110, v158, v110, v10
    v_fma_f32 v111, v158, v111, v11
    v_fma_f32 v112, v158, v112, v12
    v_fma_f32 v113, v158, v113, v13
    v_fma_f32 v114, v158, v114, v14
    v_fma_f32 v115, v158, v115, v15
    v_fma_f32 v116, v158, v116, v16
    v_fma_f32 v117, v158, v117, v17
    v_fma_f32 v118, v158, v118, v18
    v_fma_f32 v119, v158, v119, v19
    v_fma_f32 v120, v158, v120, v20
    v_fma_f32 v121, v158, v121, v21
    v_fma_f32 v122, v158, v122, v22
    v_fma_f32 v123, v158, v123, v23
    v_fma_f32 v124, v158, v124, v24
    v_fma_f32 v125, v158, v125, v25
    v_fma_f32 v126, v158, v126, v26
    v_fma_f32 v127, v158, v127, v27
    s_mov_b32 s39, 0
L_lwt:
    ds_read_b32 v2, v6 offset:816
    s_add_u32 s39, s39, 1
    s_cmp_gt_u32 s39, 160000
    s_waitcnt lgkmcnt(0)
    s_cbranch_scc1 L_lwt_done
    v_readfirstlane_b32 s38, v2
    s_nop 0
    s_cmp_eq_u32 s38, 4
    s_cbranch_scc1 L_lwt_done
    s_sleep 1
    s_branch L_lwt

L_lwt_done:
    ds_write_b128 v161, v[108:111] offset:0
    ds_write_b128 v161, v[112:115] offset:1024
    ds_write_b128 v161, v[116:119] offset:2048
    ds_write_b128 v161, v[120:123] offset:3072
    ds_write_b128 v161, v[124:127] offset:4096
    v_mov_b32 v2, 1
    ds_write_b32 v163, v2 offset:820
    s_branch L_done

L_epi:
    s_mov_b32 s39, 0
L_tin:
    ds_read_b32 v2, v163 offset:820
    ds_read_b128 v[20:23], v161 offset:0
    ds_read_b128 v[24:27], v161 offset:1024
    ds_read_b128 v[28:31], v161 offset:2048
    ds_read_b128 v[32:35], v161 offset:3072
    ds_read_b128 v[36:39], v161 offset:4096
    s_add_u32 s39, s39, 1
    s_cmp_gt_u32 s39, 160000
    s_cbranch_scc1 L_tin_done
    s_waitcnt lgkmcnt(5)
    v_cmp_eq_u32 vcc, 0, v2
    s_cbranch_vccnz L_tin

L_tin_done:
    s_waitcnt lgkmcnt(3)
    v_fma_f32 v108, v158, v108, v20
    v_fma_f32 v109, v158, v109, v21
    v_fma_f32 v110, v158, v110, v22
    v_fma_f32 v111, v158, v111, v23
    v_fma_f32 v112, v158, v112, v24
    v_fma_f32 v113, v158, v113, v25
    v_fma_f32 v114, v158, v114, v26
    v_fma_f32 v115, v158, v115, v27
    v_cvt_pk_bf16_f32 v8, v108, v109
    v_cvt_pk_bf16_f32 v9, v110, v111
    v_cvt_pk_bf16_f32 v10, v112, v113
    v_cvt_pk_bf16_f32 v11, v114, v115
    buffer_store_dwordx4 v[8:11], v157, s[24:27], s86 offen offset:0
    s_waitcnt lgkmcnt(1)
    v_fma_f32 v116, v158, v116, v28
    v_fma_f32 v117, v158, v117, v29
    v_fma_f32 v118, v158, v118, v30
    v_fma_f32 v119, v158, v119, v31
    v_fma_f32 v120, v158, v120, v32
    v_fma_f32 v121, v158, v121, v33
    v_fma_f32 v122, v158, v122, v34
    v_fma_f32 v123, v158, v123, v35
    v_cvt_pk_bf16_f32 v12, v116, v117
    v_cvt_pk_bf16_f32 v13, v118, v119
    v_cvt_pk_bf16_f32 v14, v120, v121
    v_cvt_pk_bf16_f32 v15, v122, v123
    buffer_store_dwordx4 v[12:15], v157, s[24:27], s86 offen offset:64
    s_waitcnt lgkmcnt(0)
    v_fma_f32 v124, v158, v124, v36
    v_fma_f32 v125, v158, v125, v37
    v_fma_f32 v126, v158, v126, v38
    v_fma_f32 v127, v158, v127, v39
    v_cvt_pk_bf16_f32 v16, v124, v125
    v_cvt_pk_bf16_f32 v17, v126, v127
    buffer_store_dwordx2 v[16:17], v162, s[24:27], s86 offen offset:128
L_done:
L_end:
    s_endpgm
L_fallback:
    v_mov_b32 v19, 0
    v_mov_b32 v149, 0xff800000
    s_mov_b32 s38, 6291456

L_fb1:
    buffer_load_dwordx4 v[20:23], v150, s[8:11], s38 offen offset:0 sc1
    buffer_load_dword v28, v151, s[8:11], s38 offen offset:1024 sc1
    s_waitcnt vmcnt(0)

    v_mfma_f32_32x32x8_bf16 v[48:63], v[28:29], v[18:19], 0
    v_mfma_f32_32x32x16_bf16 v[48:63], v[20:23], v[12:15], v[48:63]
    s_nop 15
    v_max3_f32 v149, v149, v48, v49
    v_max3_f32 v149, v149, v50, v51
    v_max3_f32 v149, v149, v52, v53
    v_max3_f32 v149, v149, v54, v55
    v_max3_f32 v149, v149, v56, v57
    v_max3_f32 v149, v149, v58, v59
    v_max3_f32 v149, v149, v60, v61
    v_max3_f32 v149, v149, v62, v63
    s_add_u32 s38, s38, 2624
    s_cmp_lt_u32 s38, 6459392
    s_cbranch_scc1 L_fb1

    v_mov_b32 v1, v149
    s_nop 1
    v_permlane32_swap_b32 v149, v1
    s_nop 1
    v_max_f32 v149, v149, v1

    v_xor_b32 v149, 0x80000000, v149
    v_and_b32 v1, 0xffff0000, v149
    v_sub_f32 v2, v149, v1
    v_and_b32 v3, 0xffff0000, v2
    v_sub_f32 v2, v2, v3
    v_lshrrev_b32 v1, 16, v1
    v_or_b32 v1, v1, v3
    v_lshrrev_b32 v2, 16, v2
    v_cndmask_b32 v19, v2, v1, s[4:5]

    v_mov_b32 v128, 0
    v_mov_b32 v129, 0
    v_mov_b32 v130, 0
    v_mov_b32 v131, 0
    v_mov_b32 v132, 0
    v_mov_b32 v133, 0
    v_mov_b32 v134, 0
    v_mov_b32 v135, 0
    v_mov_b32 v136, 0
    v_mov_b32 v137, 0
    v_mov_b32 v138, 0
    v_mov_b32 v139, 0
    v_mov_b32 v140, 0
    v_mov_b32 v141, 0
    v_mov_b32 v142, 0
    v_mov_b32 v143, 0
    s_mov_b32 s38, 6291456
L_fb2:
    buffer_load_dwordx4 v[20:23], v150, s[8:11], s38 offen offset:0 sc1
    buffer_load_dword v28, v151, s[8:11], s38 offen offset:1024 sc1
    buffer_load_dwordx4 v[32:35], v152, s[8:11], s38 offen offset:1280 sc1
    buffer_load_dwordx4 v[40:43], v152, s[8:11], s38 offen offset:1952 sc1
    s_waitcnt vmcnt(0)

    v_mfma_f32_32x32x8_bf16 v[48:63], v[28:29], v[18:19], 0
    v_mfma_f32_32x32x16_bf16 v[48:63], v[20:23], v[12:15], v[48:63]
    s_nop 15
    v_exp_f32 v48, v48
    v_exp_f32 v49, v49
    v_exp_f32 v50, v50
    v_exp_f32 v51, v51
    v_exp_f32 v52, v52
    v_exp_f32 v53, v53
    v_exp_f32 v54, v54
    v_exp_f32 v55, v55
    v_exp_f32 v56, v56
    v_exp_f32 v57, v57
    v_exp_f32 v58, v58
    v_exp_f32 v59, v59
    v_exp_f32 v60, v60
    v_exp_f32 v61, v61
    v_exp_f32 v62, v62
    v_exp_f32 v63, v63
    s_nop 1
    v_smfmac_f32_32x32x32_bf16 v[128:143], v[32:35], v[48:55], v144
    v_smfmac_f32_32x32x32_bf16 v[128:143], v[40:43], v[56:63], v144
    s_nop 15
    s_add_u32 s38, s38, 2624
    s_cmp_lt_u32 s38, 6459392
    s_cbranch_scc1 L_fb2

    v_mov_b32 v3, v136
    v_mov_b32 v4, v136
    s_nop 1
    v_permlane32_swap_b32 v3, v4

    s_nop 1
    s_branch L_store
L_helper:
    s_setprio 2
    s_mov_b32 s24, s64
    s_mov_b32 s25, s65
    s_mov_b32 s26, 256
    s_mov_b32 s27, 0x00020000
    v_mov_b32 v3, 0
    s_cmp_lg_u32 s2, 0
    s_cbranch_scc1 L_h_nolead
    s_memrealtime s[72:73]
    s_waitcnt lgkmcnt(0)
    s_or_b32 s72, s72, 1
    v_mov_b32 v8, s72
    v_mov_b32 v9, s73
    s_mov_b64 exec, 1
    buffer_store_dwordx2 v[8:9], v3, s[24:27], 0 offen sc1
    s_mov_b64 exec, -1

L_h_nolead:
    s_cmp_lt_u32 s37, 236
    s_cbranch_scc1 L_h_noyz
    v_mov_b32 v20, 0
    v_mov_b32 v21, 0
    v_mov_b32 v22, 0
    v_mov_b32 v23, 0
    s_lshl_b32 s38, s37, 10
    s_add_u32 s38, s38, 7229440
    buffer_store_dwordx4 v[20:23], v150, s[8:11], s38 offen sc1

L_h_noyz:
    v_mov_b32 v1, 163584
    ds_write2_b32 v1, v3, v3 offset0:0 offset1:1
    s_mov_b32 s38, 18432
    s_waitcnt lgkmcnt(0)
    s_barrier

    s_add_u32 s12, s66, 6291456
    s_addc_u32 s13, s67, 0
    s_mov_b32 s14, 167936
    s_mov_b32 s15, 0x00020000
    v_add_u32 v1, 0, v145
    v_mul_u32_u24 v2, 205, v1
    v_lshrrev_b32 v2, 11, v2
    v_mul_u32_u24 v4, 1120, v2
    v_lshl_add_u32 v144, v145, 4, v4

    v_add_u32 v1, 64, v145
    v_mul_u32_u24 v2, 205, v1
    v_lshrrev_b32 v2, 11, v2
    v_mul_u32_u24 v4, 1120, v2
    v_lshl_add_u32 v146, v145, 4, v4

    v_add_u32 v1, 128, v145
    v_mul_u32_u24 v2, 205, v1
    v_lshrrev_b32 v2, 11, v2
    v_mul_u32_u24 v4, 1120, v2
    v_lshl_add_u32 v147, v145, 4, v4

    v_add_u32 v1, 192, v145
    v_mul_u32_u24 v2, 205, v1
    v_lshrrev_b32 v2, 11, v2
    v_mul_u32_u24 v4, 1120, v2
    v_lshl_add_u32 v148, v145, 4, v4

    v_add_u32 v1, 256, v145
    v_mul_u32_u24 v2, 205, v1
    v_lshrrev_b32 v2, 11, v2
    v_mul_u32_u24 v4, 1120, v2
    v_lshl_add_u32 v149, v145, 4, v4

    v_add_u32 v149, 4096, v149
    v_lshrrev_b32 v1, 2, v155
    v_lshl_add_u32 v1, v156, 3, v1
    v_lshlrev_b32 v1, 4, v1
    v_and_b32 v2, 1, v145
    v_lshl_add_u32 v1, v2, 3, v1
    v_bfe_u32 v2, v145, 1, 1
    v_mul_u32_u24 v2, 10240, v2
    v_add3_u32 v152, v1, v2, 0
    v_add_u32 v152, 5248, v152
    v_lshlrev_b32 v159, 4, v156
    v_add_u32 v159, 25728, v159
    v_lshrrev_b32 v1, 2, v155
    v_mul_u32_u24 v1, 1280, v1
    v_lshl_add_u32 v1, v156, 5, v1
    v_and_b32 v2, 3, v145
    v_lshl_add_u32 v1, v2, 3, v1
    v_add_u32 v157, 5248, v1
    v_add_u32 v158, 5248, v150
    v_mul_u32_u24 v161, 3072, v145
    v_lshlrev_b32 v12, 5, v145
    v_and_b32 v13, 7, v145
    v_lshlrev_b32 v13, 5, v13
    s_lshl_b32 s38, s33, 8
    s_add_u32 s38, s38, 7692288
    v_add_u32 v13, s38, v13
    s_lshl_b32 s38, s37, 5
    s_add_u32 s38, s38, 7667712
    v_mov_b32 v14, s38
    s_mov_b32 s38, 18432

    s_waitcnt vmcnt(0)
    v_mov_b32 v1, 163584
    v_mov_b32 v2, 1
    s_mov_b64 exec, 1
    ds_add_u32 v1, v2 offset:4
    s_mov_b64 exec, -1

    buffer_load_dwordx2 v[8:9], v3, s[24:27], 0 offen sc1
    s_waitcnt vmcnt(0)
    s_mov_b32 s71, 0
    v_cmp_eq_u32 vcc, 0, v8
    s_cbranch_vccz L_h_nonce_done
L_h_nonce:
    buffer_load_dwordx2 v[8:9], v3, s[24:27], 0 offen sc1
    s_add_u32 s71, s71, 1
    s_cmp_gt_u32 s71, 20000
    s_cbranch_scc1 L_h_nonce_done
    s_waitcnt vmcnt(0)
    v_cmp_eq_u32 vcc, 0, v8
    s_cbranch_vccnz L_h_nonce

L_h_nonce_done:
    s_waitcnt vmcnt(0)
    s_mov_b32 s39, 2
    s_mov_b32 s71, 0

    s_lshr_b32 s39, s37, 6
    s_add_u32 s38, s39, 0
    s_and_b32 s38, s38, 3
    s_lshl_b32 s80, s38, 11
    s_add_u32 s80, s80, 7667712
    s_sub_u32 s38, s38, 0
    s_mul_i32 s76, s38, 41984

    s_add_u32 s38, s39, 1
    s_and_b32 s38, s38, 3
    s_lshl_b32 s81, s38, 11
    s_add_u32 s81, s81, 7667712
    s_sub_u32 s38, s38, 1
    s_mul_i32 s77, s38, 41984

    s_add_u32 s38, s39, 2
    s_and_b32 s38, s38, 3
    s_lshl_b32 s82, s38, 11
    s_add_u32 s82, s82, 7667712
    s_sub_u32 s38, s38, 2
    s_mul_i32 s78, s38, 41984

    s_add_u32 s38, s39, 3
    s_and_b32 s38, s38, 3
    s_lshl_b32 s83, s38, 11
    s_add_u32 s83, s83, 7667712
    s_sub_u32 s38, s38, 3
    s_mul_i32 s79, s38, 41984

    s_mov_b32 s71, 0
L_h_cntb:
    s_sleep 1
    ds_read_b32 v2, v1
    s_add_u32 s71, s71, 1
    s_cmp_gt_u32 s71, 160000
    s_cbranch_scc1 L_h_cntb_done
    s_waitcnt lgkmcnt(0)
    v_readfirstlane_b32 s38, v2
    s_nop 0
    s_bfe_u32 s38, s38, 0x100000
    s_cmp_lg_u32 s38, 1282
    s_cbranch_scc1 L_h_cntb

L_h_cntb_done:
    s_mov_b32 s71, 0
L_pollA:
    buffer_load_dwordx4 v[36:39], v12, s[8:11], s80 offen sc1
    s_add_u32 s71, s71, 1
    s_cmp_gt_u32 s71, 20000
    s_cbranch_scc1 L_pollA_done
    s_waitcnt vmcnt(0)

    v_cmp_ne_u64 vcc, v[36:37], v[8:9]
    v_cmp_ne_u64 s[6:7], v[38:39], v[8:9]
    s_or_b64 vcc, vcc, s[6:7]
    s_cbranch_vccnz L_pollA
L_pollA_done:
    s_mov_b32 m0, 0
L_h_dma0:
    s_add_u32 s38, m0, s76
    buffer_load_dwordx4 v150, s[12:15], s38 offen offset:0 sc1 lds
    buffer_load_dwordx4 v150, s[12:15], s38 offen offset:1024 sc1 lds
    buffer_load_dwordx4 v150, s[12:15], s38 offen offset:2048 sc1 lds
    buffer_load_dwordx4 v150, s[12:15], s38 offen offset:3072 sc1 lds
    s_add_u32 m0, m0, 4096
    s_cmp_lt_u32 m0, 32768
    s_cbranch_scc1 L_h_dma0

    s_barrier
    s_waitcnt vmcnt(0)

    s_barrier
    s_mov_b32 m0, 32768
L_h_dma0b:
    s_add_u32 s38, m0, s76
    buffer_load_dwordx4 v150, s[12:15], s38 offen offset:0 sc1 lds
    buffer_load_dwordx4 v150, s[12:15], s38 offen offset:1024 sc1 lds
    buffer_load_dwordx4 v150, s[12:15], s38 offen offset:2048 sc1 lds
    buffer_load_dwordx4 v150, s[12:15], s38 offen offset:3072 sc1 lds
    s_add_u32 m0, m0, 4096
    s_cmp_lt_u32 m0, 40960
    s_cbranch_scc1 L_h_dma0b

    s_add_u32 s38, m0, s76
    buffer_load_dwordx4 v150, s[12:15], s38 offen offset:0 sc1 lds
    s_mov_b32 s71, 0
L_pollA2:
    buffer_load_dwordx4 v[40:43], v12, s[8:11], s81 offen sc1
    buffer_load_dwordx4 v[44:47], v12, s[8:11], s82 offen sc1
    buffer_load_dwordx4 v[48:51], v12, s[8:11], s83 offen sc1
    s_add_u32 s71, s71, 1
    s_cmp_gt_u32 s71, 20000
    s_cbranch_scc1 L_pollA2_done
    s_waitcnt vmcnt(0)

    v_cmp_ne_u64 vcc, v[40:41], v[8:9]
    v_cmp_ne_u64 s[6:7], v[42:43], v[8:9]
    s_or_b64 vcc, vcc, s[6:7]
    v_cmp_ne_u64 s[6:7], v[44:45], v[8:9]
    s_or_b64 vcc, vcc, s[6:7]
    v_cmp_ne_u64 s[6:7], v[46:47], v[8:9]
    s_or_b64 vcc, vcc, s[6:7]
    v_cmp_ne_u64 s[6:7], v[48:49], v[8:9]
    s_or_b64 vcc, vcc, s[6:7]
    v_cmp_ne_u64 s[6:7], v[50:51], v[8:9]
    s_or_b64 vcc, vcc, s[6:7]
    s_cbranch_vccnz L_pollA2
L_pollA2_done:
    s_getreg_b32 s96, hwreg(HW_REG_XCC_ID)
    s_and_b32 s96, s96, 0xf
    s_lshl_b32 s96, s96, 8
    v_xor_b32 v10, s96, v8
    v_mov_b32 v11, 0
    s_mov_b32 s38, 16384
    s_mov_b64 exec, 1
    buffer_store_dwordx4 v[8:11], v14, s[8:11], s38 offen sc1
    s_mov_b64 exec, -1

    s_mov_b32 m0, 41984
L_h_dma1:
    s_add_u32 s38, m0, s77
    buffer_load_dwordx4 v150, s[12:15], s38 offen offset:0 sc1 lds
    buffer_load_dwordx4 v150, s[12:15], s38 offen offset:1024 sc1 lds
    buffer_load_dwordx4 v150, s[12:15], s38 offen offset:2048 sc1 lds
    buffer_load_dwordx4 v150, s[12:15], s38 offen offset:3072 sc1 lds
    s_add_u32 m0, m0, 4096
    s_cmp_lt_u32 m0, 82944
    s_cbranch_scc1 L_h_dma1

    s_add_u32 s38, m0, s77
    buffer_load_dwordx4 v150, s[12:15], s38 offen offset:0 sc1 lds
    s_mov_b32 m0, 83968
L_h_dma2:
    s_add_u32 s38, m0, s78
    buffer_load_dwordx4 v150, s[12:15], s38 offen offset:0 sc1 lds
    buffer_load_dwordx4 v150, s[12:15], s38 offen offset:1024 sc1 lds
    buffer_load_dwordx4 v150, s[12:15], s38 offen offset:2048 sc1 lds
    buffer_load_dwordx4 v150, s[12:15], s38 offen offset:3072 sc1 lds
    s_add_u32 m0, m0, 4096
    s_cmp_lt_u32 m0, 124928
    s_cbranch_scc1 L_h_dma2

    s_add_u32 s38, m0, s78
    buffer_load_dwordx4 v150, s[12:15], s38 offen offset:0 sc1 lds
    s_waitcnt vmcnt(30)
    s_cmp_ge_u32 s2, 192
    s_cbranch_scc1 L_h_nod
    s_and_b32 s68, s2, 7
    s_mul_i32 s68, s68, 24
    s_lshr_b32 s38, s2, 3
    s_add_u32 s68, s68, s38

    s_mov_b32 s20, s58
    s_mov_b32 s21, s59
    s_mov_b32 s22, 1966080
    s_mov_b32 s23, 0x00020000
    s_mul_i32 s38, s68, 10240
    buffer_load_dwordx4 v[100:103], v150, s[20:23], s38 offen offset:0
    buffer_load_dwordx4 v[104:107], v150, s[20:23], s38 offen offset:1024
    buffer_load_dwordx4 v[108:111], v150, s[20:23], s38 offen offset:2048
    buffer_load_dwordx4 v[112:115], v150, s[20:23], s38 offen offset:3072
    s_add_u32 s38, s38, 4096
    buffer_load_dwordx4 v[116:119], v150, s[20:23], s38 offen offset:0
    buffer_load_dwordx4 v[120:123], v150, s[20:23], s38 offen offset:1024
    buffer_load_dwordx4 v[124:127], v150, s[20:23], s38 offen offset:2048
    buffer_load_dwordx4 v[128:131], v150, s[20:23], s38 offen offset:3072
    s_add_u32 s38, s38, 4096
    buffer_load_dwordx4 v[132:135], v150, s[20:23], s38 offen offset:0
    buffer_load_dwordx4 v[136:139], v150, s[20:23], s38 offen offset:1024
L_h_nod:
    s_barrier
    s_mov_b32 m0, 125952
L_h_dma3:
    s_add_u32 s38, m0, s79
    buffer_load_dwordx4 v150, s[12:15], s38 offen offset:0 sc1 lds
    buffer_load_dwordx4 v150, s[12:15], s38 offen offset:1024 sc1 lds
    buffer_load_dwordx4 v150, s[12:15], s38 offen offset:2048 sc1 lds
    buffer_load_dwordx4 v150, s[12:15], s38 offen offset:3072 sc1 lds
    s_add_u32 m0, m0, 4096
    s_cmp_lt_u32 m0, 162816
    s_cbranch_scc1 L_h_dma3

    s_add_u32 s79, s79, 162688
    s_mov_b32 m0, 0
L_h_dma4:
    s_add_u32 s38, m0, s79
    buffer_load_dwordx4 v150, s[12:15], s38 offen offset:0 sc1 lds
    buffer_load_dwordx4 v150, s[12:15], s38 offen offset:1024 sc1 lds
    buffer_load_dwordx4 v150, s[12:15], s38 offen offset:2048 sc1 lds
    buffer_load_dwordx4 v150, s[12:15], s38 offen offset:3072 sc1 lds
    s_add_u32 m0, m0, 4096
    s_cmp_lt_u32 m0, 4096
    s_cbranch_scc1 L_h_dma4

    s_add_u32 s38, m0, s79
    buffer_load_dwordx4 v150, s[12:15], s38 offen offset:0 sc1 lds
    s_mov_b64 exec, 0xff
    buffer_load_dwordx4 v150, s[12:15], s38 offen offset:1024 sc1 lds
    s_mov_b64 exec, -1
    s_mov_b32 s71, 0
    s_mov_b32 s39, 7684096
    s_mov_b32 s38, 7688192
L_pollK:
    buffer_load_dwordx2 v[84:85], v12, s[8:11], s39 offen offset:0 sc1
    buffer_load_dwordx2 v[86:87], v12, s[8:11], s39 offen offset:2048 sc1
    buffer_load_dwordx2 v[88:89], v12, s[8:11], s38 offen offset:0 sc1
    buffer_load_dwordx2 v[90:91], v12, s[8:11], s38 offen offset:2048 sc1
    s_add_u32 s71, s71, 1
    s_cmp_gt_u32 s71, 20000
    s_cbranch_scc1 L_pollK_done
    s_waitcnt vmcnt(0)

    v_cmp_ne_u64 vcc, v[84:85], v[8:9]
    v_cmp_ne_u64 s[6:7], v[86:87], v[8:9]
    s_or_b64 vcc, vcc, s[6:7]
    v_cmp_ne_u64 s[6:7], v[88:89], v[8:9]
    s_or_b64 vcc, vcc, s[6:7]
    v_cmp_ne_u64 s[6:7], v[90:91], v[8:9]
    s_or_b64 vcc, vcc, s[6:7]
    s_cbranch_vccnz L_pollK
L_pollK_done:
    s_mov_b32 s38, 4294959104
    v_add_u32 v2, s38, v13
    buffer_load_dword v3, v2, s[8:11], 0 offen offset:8 sc1
    v_lshlrev_b32 v1, 3, v145
    s_mov_b32 s38, 7405568
    buffer_load_dwordx2 v[16:17], v1, s[8:11], s38 offen sc1
    s_cmp_lg_u32 s2, 0
    s_cbranch_scc1 L_h_noreset
    v_mov_b32 v24, 0
    v_mov_b32 v25, 0
    s_mov_b64 exec, 1
    buffer_store_dwordx2 v[24:25], v24, s[24:27], 0 offen sc1
    s_mov_b64 exec, -1

L_h_noreset:
    v_mov_b32 v20, -1
    v_mov_b32 v21, -1
    v_mov_b32 v22, -1
    v_mov_b32 v23, -1
    s_mul_i32 s38, s37, 10240
    s_add_u32 s38, s38, 3145728
    s_waitcnt vmcnt(0)
    v_cmp_ne_u32 vcc, v10, v3
    s_mov_b32 s97, 0
    s_cbranch_vccnz L_h_mk_slow
    s_mov_b32 s97, 1

    buffer_store_dwordx4 v[20:23], v150, s[8:11], s38 offen offset:0
    buffer_store_dwordx4 v[20:23], v150, s[8:11], s38 offen offset:1024
    buffer_store_dwordx4 v[20:23], v150, s[8:11], s38 offen offset:2048
    buffer_store_dwordx4 v[20:23], v150, s[8:11], s38 offen offset:3072
    s_add_u32 s38, s38, 4096
    buffer_store_dwordx4 v[20:23], v150, s[8:11], s38 offen
    s_add_u32 s38, s38, 1024
    buffer_store_dwordx4 v[20:23], v150, s[8:11], s38 offen offset:0
    buffer_store_dwordx4 v[20:23], v150, s[8:11], s38 offen offset:1024
    buffer_store_dwordx4 v[20:23], v150, s[8:11], s38 offen offset:2048
    buffer_store_dwordx4 v[20:23], v150, s[8:11], s38 offen offset:3072
    s_add_u32 s38, s38, 4096
    buffer_store_dwordx4 v[20:23], v150, s[8:11], s38 offen
    s_add_u32 s38, s38, 1024
    s_branch L_h_mk_done
L_h_mk_slow:
    buffer_store_dwordx4 v[20:23], v150, s[8:11], s38 offen offset:0 sc1
    buffer_store_dwordx4 v[20:23], v150, s[8:11], s38 offen offset:1024 sc1
    buffer_store_dwordx4 v[20:23], v150, s[8:11], s38 offen offset:2048 sc1
    buffer_store_dwordx4 v[20:23], v150, s[8:11], s38 offen offset:3072 sc1
    s_add_u32 s38, s38, 4096
    buffer_store_dwordx4 v[20:23], v150, s[8:11], s38 offen sc1
    s_add_u32 s38, s38, 1024
    buffer_store_dwordx4 v[20:23], v150, s[8:11], s38 offen offset:0 sc1
    buffer_store_dwordx4 v[20:23], v150, s[8:11], s38 offen offset:1024 sc1
    buffer_store_dwordx4 v[20:23], v150, s[8:11], s38 offen offset:2048 sc1
    buffer_store_dwordx4 v[20:23], v150, s[8:11], s38 offen offset:3072 sc1
    s_add_u32 s38, s38, 4096
    buffer_store_dwordx4 v[20:23], v150, s[8:11], s38 offen sc1
    s_add_u32 s38, s38, 1024
L_h_mk_done:
    v_max_u32 v16, v16, v17
    s_nop 1
    v_max_u32_dpp v16, v16, v16 row_shr:1 row_mask:0xf bank_mask:0xf
    s_nop 1
    v_max_u32_dpp v16, v16, v16 row_shr:2 row_mask:0xf bank_mask:0xf
    s_nop 1
    v_max_u32_dpp v16, v16, v16 row_shr:4 row_mask:0xf bank_mask:0xf
    s_nop 1
    v_max_u32_dpp v16, v16, v16 row_shr:8 row_mask:0xf bank_mask:0xf
    s_nop 1
    v_readlane_b32 s70, v16, 15
    v_readlane_b32 s38, v16, 31
    v_readlane_b32 s39, v16, 47
    v_readlane_b32 s69, v16, 63
    s_nop 3
    s_max_u32 s70, s70, s38
    s_max_u32 s39, s39, s69
    s_max_u32 s70, s70, s39
    s_and_b32 s69, s70, 0x7ff
    s_sub_u32 s69, 2047, s69
    s_lshl_b32 s38, s33, 8
    s_add_u32 s38, s38, 7340032
    s_mov_b32 m0, 163344
    s_nop 0
    buffer_load_dword v151, s[8:11], s38 offen sc1 lds
    s_mul_i32 s38, s69, 1280
    s_mov_b32 m0, 25728
    s_nop 0
    buffer_load_dwordx4 v150, s[16:19], s38 offen lds
    s_mov_b64 exec, 0xffff
    buffer_load_dwordx4 v150, s[16:19], s38 offen offset:1024 lds
    s_mov_b64 exec, -1

    s_cmp_ge_u32 s2, 192
    s_cbranch_scc1 L_h_noslab
    s_and_b32 s68, s2, 7
    s_mul_i32 s68, s68, 24
    s_lshr_b32 s38, s2, 3
    s_add_u32 s68, s68, s38

    s_mov_b32 s20, s54
    s_mov_b32 s21, s55
    s_mov_b32 s22, 1966080
    s_mov_b32 s23, 0x00020000
    s_mov_b32 s28, s56
    s_mov_b32 s29, s57
    s_mov_b32 s30, 1966080
    s_mov_b32 s31, 0x00020000
    s_and_b32 s71, s68, 7
    s_mov_b32 s76, 0

L_h_slab:
    s_lshl_b32 s39, s71, 10
    s_add_u32 m0, s39, 5248
    s_mul_i32 s38, s71, 196608
    s_lshl_b32 s77, s68, 4
    s_add_u32 s38, s38, s77
    buffer_load_dwordx4 v161, s[20:23], s38 offen lds
    s_add_u32 m0, s39, 15488
    s_add_u32 s71, s71, 1
    buffer_load_dwordx4 v161, s[28:31], s38 offen lds
    s_cmp_eq_u32 s71, 10
    s_cselect_b32 s71, 0, s71
    s_add_u32 s76, s76, 1
    s_cmp_lt_u32 s76, 10
    s_cbranch_scc1 L_h_slab

L_h_noslab:
L_h_l3:
    s_mov_b32 s20, s48
    s_mov_b32 s21, s49
    s_mov_b32 s22, 819200
    s_mov_b32 s23, 0x00020000
    s_mul_i32 s75, s34, 160
    s_mov_b32 s71, 29824

    v_mov_b32 v2, 0
    v_mov_b32 v1, 162816
    ds_write2_b32 v1, v2, v2 offset0:1 offset1:2
    ds_write_b32 v1, v2 offset:12
    v_add_u32 v1, 163600, v151
    s_mov_b64 exec, 0xffff
    ds_write_b32 v1, v2
    s_mov_b64 exec, -1
    s_waitcnt lgkmcnt(0)

    s_barrier
    s_mul_i32 s75, s34, 160
    s_add_u32 s75, s75, 0
    s_mov_b32 s71, 29824
L_wo1:
    s_add_u32 m0, s71, 0
    s_add_u32 s38, s75, 0
    buffer_load_dwordx4 v144, s[20:23], s38 offen offset:0 lds
    buffer_load_dwordx4 v146, s[20:23], s38 offen offset:1024 lds
    buffer_load_dwordx4 v147, s[20:23], s38 offen offset:2048 lds
    buffer_load_dwordx4 v148, s[20:23], s38 offen offset:3072 lds
    s_add_u32 m0, s71, 4096
    s_nop 0
    buffer_load_dwordx4 v149, s[20:23], s38 offen lds
    s_add_u32 m0, s71, 5120
    s_add_u32 s38, s75, 40960
    buffer_load_dwordx4 v144, s[20:23], s38 offen offset:0 lds
    buffer_load_dwordx4 v146, s[20:23], s38 offen offset:1024 lds
    buffer_load_dwordx4 v147, s[20:23], s38 offen offset:2048 lds
    buffer_load_dwordx4 v148, s[20:23], s38 offen offset:3072 lds
    s_add_u32 m0, s71, 9216
    s_nop 0
    buffer_load_dwordx4 v149, s[20:23], s38 offen lds
    s_add_u32 m0, s71, 10240
    s_add_u32 s38, s75, 81920
    buffer_load_dwordx4 v144, s[20:23], s38 offen offset:0 lds
    buffer_load_dwordx4 v146, s[20:23], s38 offen offset:1024 lds
    s_mov_b64 exec, s[4:5]
    buffer_load_dwordx4 v147, s[20:23], s38 offen offset:2048 lds
    s_mov_b64 exec, -1
    s_add_u32 s75, s75, 204800
    s_add_u32 s71, s71, 12800
    s_cmp_lt_u32 s71, 81024
    s_cbranch_scc1 L_wo1

    s_waitcnt vmcnt(52)
    s_mov_b32 s38, 24576
    s_mov_b64 exec, 1
    buffer_store_dwordx2 v[8:9], v14, s[8:11], s38 offen sc1
    s_mov_b64 exec, -1

    s_cmp_ge_u32 s2, 192
    s_cbranch_scc1 L_h_ffn_done

    ds_read_b64_tr_b16 v[52:53], v152 offset:0
    ds_read_b64_tr_b16 v[54:55], v152 offset:64
    ds_read_b128 v[56:59], v159 offset:0
    ds_read_b64_tr_b16 v[60:61], v152 offset:512
    ds_read_b64_tr_b16 v[62:63], v152 offset:576
    ds_read_b128 v[64:67], v159 offset:64
    ds_read_b64_tr_b16 v[68:69], v152 offset:1024
    ds_read_b64_tr_b16 v[70:71], v152 offset:1088
    ds_read_b128 v[72:75], v159 offset:128
    ds_read_b64_tr_b16 v[76:77], v152 offset:1536
    ds_read_b64_tr_b16 v[78:79], v152 offset:1600
    ds_read_b128 v[80:83], v159 offset:192
    s_waitcnt lgkmcnt(9)
    v_mfma_f32_16x16x32_bf16 v[48:51], v[56:59], v[52:55], 0
    ds_read_b64_tr_b16 v[52:53], v152 offset:2048
    ds_read_b64_tr_b16 v[54:55], v152 offset:2112
    ds_read_b128 v[56:59], v159 offset:256
    s_waitcnt lgkmcnt(9)
    v_mfma_f32_16x16x32_bf16 v[48:51], v[64:67], v[60:63], v[48:51]
    ds_read_b64_tr_b16 v[60:61], v152 offset:2560
    ds_read_b64_tr_b16 v[62:63], v152 offset:2624
    ds_read_b128 v[64:67], v159 offset:320
    s_waitcnt lgkmcnt(9)
    v_mfma_f32_16x16x32_bf16 v[48:51], v[72:75], v[68:71], v[48:51]
    ds_read_b64_tr_b16 v[68:69], v152 offset:3072
    ds_read_b64_tr_b16 v[70:71], v152 offset:3136
    ds_read_b128 v[72:75], v159 offset:384
    s_waitcnt lgkmcnt(9)
    v_mfma_f32_16x16x32_bf16 v[48:51], v[80:83], v[76:79], v[48:51]
    ds_read_b64_tr_b16 v[76:77], v152 offset:3584
    ds_read_b64_tr_b16 v[78:79], v152 offset:3648
    ds_read_b128 v[80:83], v159 offset:448
    s_waitcnt lgkmcnt(9)
    v_mfma_f32_16x16x32_bf16 v[48:51], v[56:59], v[52:55], v[48:51]
    ds_read_b64_tr_b16 v[52:53], v152 offset:4096
    ds_read_b64_tr_b16 v[54:55], v152 offset:4160
    ds_read_b128 v[56:59], v159 offset:512
    s_waitcnt lgkmcnt(9)
    v_mfma_f32_16x16x32_bf16 v[48:51], v[64:67], v[60:63], v[48:51]
    ds_read_b64_tr_b16 v[60:61], v152 offset:4608
    ds_read_b64_tr_b16 v[62:63], v152 offset:4672
    ds_read_b128 v[64:67], v159 offset:576
    s_waitcnt lgkmcnt(9)
    v_mfma_f32_16x16x32_bf16 v[48:51], v[72:75], v[68:71], v[48:51]
    ds_read_b64_tr_b16 v[68:69], v152 offset:5120
    ds_read_b64_tr_b16 v[70:71], v152 offset:5184
    ds_read_b128 v[72:75], v159 offset:640
    s_waitcnt lgkmcnt(9)
    v_mfma_f32_16x16x32_bf16 v[48:51], v[80:83], v[76:79], v[48:51]
    ds_read_b64_tr_b16 v[76:77], v152 offset:5632
    ds_read_b64_tr_b16 v[78:79], v152 offset:5696
    ds_read_b128 v[80:83], v159 offset:704
    s_waitcnt lgkmcnt(9)
    v_mfma_f32_16x16x32_bf16 v[48:51], v[56:59], v[52:55], v[48:51]
    ds_read_b64_tr_b16 v[52:53], v152 offset:6144
    ds_read_b64_tr_b16 v[54:55], v152 offset:6208
    ds_read_b128 v[56:59], v159 offset:768
    s_waitcnt lgkmcnt(9)
    v_mfma_f32_16x16x32_bf16 v[48:51], v[64:67], v[60:63], v[48:51]
    ds_read_b64_tr_b16 v[60:61], v152 offset:6656
    ds_read_b64_tr_b16 v[62:63], v152 offset:6720
    ds_read_b128 v[64:67], v159 offset:832
    s_waitcnt lgkmcnt(9)
    v_mfma_f32_16x16x32_bf16 v[48:51], v[72:75], v[68:71], v[48:51]
    ds_read_b64_tr_b16 v[68:69], v152 offset:7168
    ds_read_b64_tr_b16 v[70:71], v152 offset:7232
    ds_read_b128 v[72:75], v159 offset:896
    s_waitcnt lgkmcnt(9)
    v_mfma_f32_16x16x32_bf16 v[48:51], v[80:83], v[76:79], v[48:51]
    ds_read_b64_tr_b16 v[76:77], v152 offset:7680
    ds_read_b64_tr_b16 v[78:79], v152 offset:7744
    ds_read_b128 v[80:83], v159 offset:960
    s_waitcnt lgkmcnt(9)
    v_mfma_f32_16x16x32_bf16 v[48:51], v[56:59], v[52:55], v[48:51]
    ds_read_b64_tr_b16 v[52:53], v152 offset:8192
    ds_read_b64_tr_b16 v[54:55], v152 offset:8256
    ds_read_b128 v[56:59], v159 offset:1024
    s_waitcnt lgkmcnt(9)
    v_mfma_f32_16x16x32_bf16 v[48:51], v[64:67], v[60:63], v[48:51]
    ds_read_b64_tr_b16 v[60:61], v152 offset:8704
    ds_read_b64_tr_b16 v[62:63], v152 offset:8768
    ds_read_b128 v[64:67], v159 offset:1088
    s_waitcnt lgkmcnt(9)
    v_mfma_f32_16x16x32_bf16 v[48:51], v[72:75], v[68:71], v[48:51]
    ds_read_b64_tr_b16 v[68:69], v152 offset:9216
    ds_read_b64_tr_b16 v[70:71], v152 offset:9280
    ds_read_b128 v[72:75], v159 offset:1152
    s_waitcnt lgkmcnt(9)
    v_mfma_f32_16x16x32_bf16 v[48:51], v[80:83], v[76:79], v[48:51]
    ds_read_b64_tr_b16 v[76:77], v152 offset:9728
    ds_read_b64_tr_b16 v[78:79], v152 offset:9792
    ds_read_b128 v[80:83], v159 offset:1216
    s_waitcnt lgkmcnt(9)
    v_mfma_f32_16x16x32_bf16 v[48:51], v[56:59], v[52:55], v[48:51]
    s_waitcnt lgkmcnt(6)
    v_mfma_f32_16x16x32_bf16 v[48:51], v[64:67], v[60:63], v[48:51]
    s_waitcnt lgkmcnt(3)
    v_mfma_f32_16x16x32_bf16 v[48:51], v[72:75], v[68:71], v[48:51]
    s_waitcnt lgkmcnt(0)
    v_mfma_f32_16x16x32_bf16 v[48:51], v[80:83], v[76:79], v[48:51]
    ds_write_b128 v158, v[100:103] offset:0
    ds_write_b128 v158, v[104:107] offset:1024
    ds_write_b128 v158, v[108:111] offset:2048
    ds_write_b128 v158, v[112:115] offset:3072
    ds_write_b128 v158, v[116:119] offset:4096
    ds_write_b128 v158, v[120:123] offset:5120
    ds_write_b128 v158, v[124:127] offset:6144
    ds_write_b128 v158, v[128:131] offset:7168
    ds_write_b128 v158, v[132:135] offset:8192
    ds_write_b128 v158, v[136:139] offset:9216
    v_mov_b32_dpp v21, v48 row_ror:8 row_mask:0xf bank_mask:0xf
    v_mov_b32 v24, 0
    v_cvt_pk_bf16_f32 v20, v48, v21
    v_and_b32 v21, 0xffff0000, v20
    v_lshlrev_b32 v20, 16, v20
    v_mul_f32 v22, 0xbfb8aa3b, v20
    v_exp_f32 v22, v22
    v_mov_b32 v25, 0
    v_add_f32 v22, 1.0, v22
    v_rcp_f32 v22, v22
    v_mov_b32 v26, 0
    v_mul_f32 v20, v20, v22
    v_cvt_pk_bf16_f32 v20, v20, v20
    v_and_b32 v20, 0xffff0000, v20
    v_mul_f32 v20, v20, v21
    v_mov_b32 v27, 0
    s_nop 0
    v_mov_b32_dpp v21, v20 quad_perm:[1,0,3,2] row_mask:0xf bank_mask:0xf
    v_cvt_pk_bf16_f32 v20, v20, v21
    s_mov_b32 s38, 0x00100001
    s_mov_b32 s39, 0x10000100
    v_readlane_b32 s76, v20, 0
    v_readlane_b32 s77, v20, 2
    v_readlane_b32 s78, v20, 4
    v_readlane_b32 s79, v20, 6
    s_mov_b64 exec, s[38:39]
    s_nop 0
    v_mov_b32 v24, s76
    v_mov_b32 v25, s77
    v_mov_b32 v26, s78
    v_mov_b32 v27, s79
    s_mov_b64 exec, -1
    s_waitcnt lgkmcnt(0)

    ds_read_b64_tr_b16 v[100:101], v157 offset:0
    ds_read_b64_tr_b16 v[102:103], v157 offset:5120
    ds_read_b64_tr_b16 v[104:105], v157 offset:128
    ds_read_b64_tr_b16 v[106:107], v157 offset:5248
    ds_read_b64_tr_b16 v[108:109], v157 offset:256
    ds_read_b64_tr_b16 v[110:111], v157 offset:5376
    ds_read_b64_tr_b16 v[112:113], v157 offset:384
    ds_read_b64_tr_b16 v[114:115], v157 offset:5504
    ds_read_b64_tr_b16 v[116:117], v157 offset:512
    ds_read_b64_tr_b16 v[118:119], v157 offset:5632
    s_waitcnt lgkmcnt(0)
    v_mfma_f32_16x16x32_bf16 v[28:31], v[24:27], v[100:103], 0
    v_mfma_f32_16x16x32_bf16 v[32:35], v[24:27], v[104:107], 0
    v_mfma_f32_16x16x32_bf16 v[36:39], v[24:27], v[108:111], 0
    v_mfma_f32_16x16x32_bf16 v[40:43], v[24:27], v[112:115], 0
    v_mfma_f32_16x16x32_bf16 v[44:47], v[24:27], v[116:119], 0
    ds_read_b64_tr_b16 v[120:121], v157 offset:640
    ds_read_b64_tr_b16 v[122:123], v157 offset:5760
    ds_read_b64_tr_b16 v[124:125], v157 offset:768
    ds_read_b64_tr_b16 v[126:127], v157 offset:5888
    ds_read_b64_tr_b16 v[128:129], v157 offset:896
    ds_read_b64_tr_b16 v[130:131], v157 offset:6016
    ds_read_b64_tr_b16 v[132:133], v157 offset:1024
    ds_read_b64_tr_b16 v[134:135], v157 offset:6144
    ds_read_b64_tr_b16 v[136:137], v157 offset:1152
    ds_read_b64_tr_b16 v[138:139], v157 offset:6272
    s_waitcnt lgkmcnt(0)
    v_mfma_f32_16x16x32_bf16 v[48:51], v[24:27], v[120:123], 0
    v_mfma_f32_16x16x32_bf16 v[52:55], v[24:27], v[124:127], 0
    v_mfma_f32_16x16x32_bf16 v[56:59], v[24:27], v[128:131], 0
    v_mfma_f32_16x16x32_bf16 v[60:63], v[24:27], v[132:135], 0
    v_mfma_f32_16x16x32_bf16 v[64:67], v[24:27], v[136:139], 0
    s_and_b32 s38, s2, 7
    s_mul_i32 s38, s38, 2560
    s_add_u32 s38, s38, 7471104
    s_nop 4

    buffer_atomic_add_f32 v28, v151, s[8:11], s38 offen offset:0 sc1
    buffer_atomic_add_f32 v32, v151, s[8:11], s38 offen offset:256 sc1
    buffer_atomic_add_f32 v36, v151, s[8:11], s38 offen offset:512 sc1
    buffer_atomic_add_f32 v40, v151, s[8:11], s38 offen offset:768 sc1
    buffer_atomic_add_f32 v44, v151, s[8:11], s38 offen offset:1024 sc1
    buffer_atomic_add_f32 v48, v151, s[8:11], s38 offen offset:1280 sc1
    buffer_atomic_add_f32 v52, v151, s[8:11], s38 offen offset:1536 sc1
    buffer_atomic_add_f32 v56, v151, s[8:11], s38 offen offset:1792 sc1
    buffer_atomic_add_f32 v60, v151, s[8:11], s38 offen offset:2048 sc1
    buffer_atomic_add_f32 v64, v151, s[8:11], s38 offen offset:2304 sc1
L_h_ffn_done:
    s_mov_b32 s71, 0
L_pollC:
    buffer_load_dwordx2 v[84:85], v13, s[8:11], 0 offen sc1
    s_add_u32 s71, s71, 1
    s_cmp_gt_u32 s71, 20000
    s_cbranch_scc1 L_pollC_done
    s_waitcnt vmcnt(0)
    v_cmp_ne_u64 vcc, v[84:85], v[8:9]
    s_cbranch_vccnz L_pollC

L_pollC_done:
    s_waitcnt vmcnt(0)
    v_mov_b32 v1, 162816
    s_and_b32 s39, s69, 63
    s_lshr_b32 s38, s69, 6
    s_cmp_eq_u32 s38, s33
    s_cselect_b32 s39, s39, -1
    v_mov_b32 v2, s39
    s_lshl_b32 s39, s97, 1
    s_or_b32 s39, s39, 1
    v_mov_b32 v3, s39
    ds_write2_b32 v1, v2, v3 offset0:0 offset1:1
    v_add_u32 v1, 8, v1

    s_mov_b32 s38, 8192
    s_mov_b64 exec, 1
    buffer_store_dwordx2 v[8:9], v14, s[8:11], s38 offen sc1
    s_mov_b64 exec, -1

    s_lshr_b32 s38, s69, 6
    s_cmp_lg_u32 s38, s33
    s_cbranch_scc1 L_h_nosel

    s_mov_b32 s71, 0
    s_mov_b32 s39, 7675904
    s_mov_b32 s38, 7680000
L_pollB:
    buffer_load_dwordx2 v[84:85], v12, s[8:11], s39 offen offset:0 sc1
    buffer_load_dwordx2 v[86:87], v12, s[8:11], s39 offen offset:2048 sc1
    buffer_load_dwordx2 v[88:89], v12, s[8:11], s38 offen offset:0 sc1
    buffer_load_dwordx2 v[90:91], v12, s[8:11], s38 offen offset:2048 sc1
    s_add_u32 s71, s71, 1
    s_cmp_gt_u32 s71, 20000
    s_cbranch_scc1 L_pollB_done
    s_waitcnt vmcnt(0)

    v_cmp_ne_u64 vcc, v[84:85], v[8:9]
    v_cmp_ne_u64 s[6:7], v[86:87], v[8:9]
    s_or_b64 vcc, vcc, s[6:7]
    v_cmp_ne_u64 s[6:7], v[88:89], v[8:9]
    s_or_b64 vcc, vcc, s[6:7]
    v_cmp_ne_u64 s[6:7], v[90:91], v[8:9]
    s_or_b64 vcc, vcc, s[6:7]
    s_cbranch_vccz L_pollB_done
    s_sleep 8
    s_branch L_pollB
L_pollB_done:
    s_and_b32 s38, s70, 0xfffff800
    s_not_b32 s39, s38
    s_and_b32 s38, s38, 0x7fffffff
    s_cmp_lt_i32 s70, 0
    s_cselect_b32 s38, s38, s39
    v_mov_b32 v6, s38
    v_cvt_pk_bf16_f32 v6, v6, v6
    v_and_b32 v6, 0xffff0000, v6
    v_mul_f32 v6, 0xbfb8aa3b, v6
    v_exp_f32 v6, v6
    s_nop 0
    v_add_f32 v6, 1.0, v6
    v_rcp_f32 v6, v6
    s_nop 0
    v_cvt_pk_bf16_f32 v6, v6, v6
    v_and_b32 v6, 0xffff0000, v6
    s_mul_i32 s38, s34, 80

    v_add_u32 v3, s38, v145
    v_add_u32 v3, 0, v3
    v_min_u32 v3, 639, v3
    v_lshlrev_b32 v4, 2, v3
    s_mov_b32 s39, 7471104

    buffer_load_dword v20, v4, s[8:11], s39 offen sc1
    s_add_u32 s39, s39, 2560
    buffer_load_dword v21, v4, s[8:11], s39 offen sc1
    s_add_u32 s39, s39, 2560
    buffer_load_dword v22, v4, s[8:11], s39 offen sc1
    s_add_u32 s39, s39, 2560
    buffer_load_dword v23, v4, s[8:11], s39 offen sc1
    s_add_u32 s39, s39, 2560
    buffer_load_dword v24, v4, s[8:11], s39 offen sc1
    s_add_u32 s39, s39, 2560
    buffer_load_dword v25, v4, s[8:11], s39 offen sc1
    s_add_u32 s39, s39, 2560
    buffer_load_dword v26, v4, s[8:11], s39 offen sc1
    s_add_u32 s39, s39, 2560
    buffer_load_dword v27, v4, s[8:11], s39 offen sc1
    s_add_u32 s39, s39, 2560
    v_add_u32 v3, s38, v145
    v_add_u32 v3, 64, v3
    v_min_u32 v3, 639, v3
    v_lshlrev_b32 v4, 2, v3
    s_mov_b32 s39, 7471104

    buffer_load_dword v28, v4, s[8:11], s39 offen sc1
    s_add_u32 s39, s39, 2560
    buffer_load_dword v29, v4, s[8:11], s39 offen sc1
    s_add_u32 s39, s39, 2560
    buffer_load_dword v30, v4, s[8:11], s39 offen sc1
    s_add_u32 s39, s39, 2560
    buffer_load_dword v31, v4, s[8:11], s39 offen sc1
    s_add_u32 s39, s39, 2560
    buffer_load_dword v32, v4, s[8:11], s39 offen sc1
    s_add_u32 s39, s39, 2560
    buffer_load_dword v33, v4, s[8:11], s39 offen sc1
    s_add_u32 s39, s39, 2560
    buffer_load_dword v34, v4, s[8:11], s39 offen sc1
    s_add_u32 s39, s39, 2560
    buffer_load_dword v35, v4, s[8:11], s39 offen sc1
    s_add_u32 s39, s39, 2560
    s_waitcnt vmcnt(0)
    v_add_f32 v20, v20, v21
    v_add_f32 v20, v20, v22
    v_add_f32 v20, v20, v23
    v_add_f32 v20, v20, v24
    v_add_f32 v20, v20, v25
    v_add_f32 v20, v20, v26
    v_add_f32 v20, v20, v27
    v_cvt_pk_bf16_f32 v20, v20, v20
    v_and_b32 v20, 0xffff0000, v20
    v_mul_f32 v20, v6, v20
    v_cvt_pk_bf16_f32 v20, v20, v20
    v_and_b32 v20, 0xffff0000, v20

    v_add_f32 v28, v28, v29
    v_add_f32 v28, v28, v30
    v_add_f32 v28, v28, v31
    v_add_f32 v28, v28, v32
    v_add_f32 v28, v28, v33
    v_add_f32 v28, v28, v34
    v_add_f32 v28, v28, v35
    v_cvt_pk_bf16_f32 v28, v28, v28
    v_and_b32 v28, 0xffff0000, v28
    v_mul_f32 v28, v6, v28
    v_cvt_pk_bf16_f32 v28, v28, v28
    v_and_b32 v28, 0xffff0000, v28

    v_add_u32 v3, 162832, v151
    ds_write_b32 v3, v20
    ds_write_b32 v3, v28 offset:256
    s_waitcnt lgkmcnt(0)

L_h_nosel:
    s_mul_i32 s75, s34, 160
    s_add_u32 s75, s75, 102400
    s_mov_b32 s71, 81024
L_wo2p:
    s_add_u32 m0, s71, 0
    s_add_u32 s38, s75, 0
    buffer_load_dword v80, v144, s[20:23], s38 offen offset:0
    buffer_load_dword v80, v146, s[20:23], s38 offen offset:1024
    buffer_load_dword v80, v147, s[20:23], s38 offen offset:2048
    buffer_load_dword v80, v148, s[20:23], s38 offen offset:3072
    s_add_u32 m0, s71, 4096
    s_nop 0
    buffer_load_dword v80, v149, s[20:23], s38 offen
    s_add_u32 m0, s71, 5120
    s_add_u32 s38, s75, 40960
    buffer_load_dword v80, v144, s[20:23], s38 offen offset:0
    buffer_load_dword v80, v146, s[20:23], s38 offen offset:1024
    buffer_load_dword v80, v147, s[20:23], s38 offen offset:2048
    buffer_load_dword v80, v148, s[20:23], s38 offen offset:3072
    s_add_u32 m0, s71, 9216
    s_nop 0
    buffer_load_dword v80, v149, s[20:23], s38 offen
    s_add_u32 m0, s71, 10240
    s_add_u32 s38, s75, 81920
    buffer_load_dword v80, v144, s[20:23], s38 offen offset:0
    buffer_load_dword v80, v146, s[20:23], s38 offen offset:1024
    s_mov_b64 exec, s[4:5]
    buffer_load_dword v80, v147, s[20:23], s38 offen offset:2048
    s_mov_b64 exec, -1
    s_add_u32 s75, s75, 204800
    s_add_u32 s71, s71, 12800
    s_cmp_lt_u32 s71, 132224
    s_cbranch_scc1 L_wo2p

    s_mov_b32 s71, 0
L_h_cntp:
    s_sleep 5
    ds_read_b32 v2, v1
    s_add_u32 s71, s71, 1
    s_cmp_gt_u32 s71, 160000
    s_cbranch_scc1 L_h_cntp_done
    s_waitcnt lgkmcnt(0)
    v_readfirstlane_b32 s38, v2
    s_nop 0
    s_bfe_u32 s38, s38, 0x100000
    s_cmp_lg_u32 s38, 8
    s_cbranch_scc1 L_h_cntp

L_h_cntp_done:
    s_mul_i32 s75, s34, 160
    s_add_u32 s75, s75, 102400
    s_mov_b32 s71, 81024
L_wo2:
    s_add_u32 m0, s71, 0
    s_add_u32 s38, s75, 0
    buffer_load_dwordx4 v144, s[20:23], s38 offen offset:0 lds
    buffer_load_dwordx4 v146, s[20:23], s38 offen offset:1024 lds
    buffer_load_dwordx4 v147, s[20:23], s38 offen offset:2048 lds
    buffer_load_dwordx4 v148, s[20:23], s38 offen offset:3072 lds
    s_add_u32 m0, s71, 4096
    s_nop 0
    buffer_load_dwordx4 v149, s[20:23], s38 offen lds
    s_add_u32 m0, s71, 5120
    s_add_u32 s38, s75, 40960
    buffer_load_dwordx4 v144, s[20:23], s38 offen offset:0 lds
    buffer_load_dwordx4 v146, s[20:23], s38 offen offset:1024 lds
    buffer_load_dwordx4 v147, s[20:23], s38 offen offset:2048 lds
    buffer_load_dwordx4 v148, s[20:23], s38 offen offset:3072 lds
    s_add_u32 m0, s71, 9216
    s_nop 0
    buffer_load_dwordx4 v149, s[20:23], s38 offen lds
    s_add_u32 m0, s71, 10240
    s_add_u32 s38, s75, 81920
    buffer_load_dwordx4 v144, s[20:23], s38 offen offset:0 lds
    buffer_load_dwordx4 v146, s[20:23], s38 offen offset:1024 lds
    s_mov_b64 exec, s[4:5]
    buffer_load_dwordx4 v147, s[20:23], s38 offen offset:2048 lds
    s_mov_b64 exec, -1
    s_add_u32 s75, s75, 204800
    s_add_u32 s71, s71, 12800
    s_cmp_lt_u32 s71, 132224
    s_cbranch_scc1 L_wo2

    v_mov_b32 v2, 1
    s_waitcnt vmcnt(0)
    ds_write_b32 v1, v2 offset:4

    s_endpgm
L_code_end:
.section .rodata,"a"
.p2align 6
.amdhsa_kernel gated_mix__grouped_kv_mqa__moe_arch_mod__prompt_kernel
  .amdhsa_next_free_vgpr 168
  .amdhsa_next_free_sgpr 102
  .amdhsa_accum_offset 168
  .amdhsa_group_segment_fixed_size 0
  .amdhsa_kernarg_size 112
  .amdhsa_user_sgpr_count 2
  .amdhsa_user_sgpr_kernarg_segment_ptr 1
  .amdhsa_system_sgpr_workgroup_id_x 1
.end_amdhsa_kernel
```
